```python
import torch

def _softmax(x, axis=-1):
    return torch.softmax(x, dim=axis)
def _gelu(x):
    return torch.nn.functional.gelu(x, approximate="tanh")
def _silu(x):
    return torch.nn.functional.silu(x)
def _sigmoid(x):
    return torch.sigmoid(x)
def _layernorm(x, axis=-1, eps=1e-5):
    m = x.mean(dim=axis, keepdim=True)
    v = x.var(dim=axis, keepdim=True, unbiased=False)
    return (x - m) / torch.sqrt(v + eps)
def _scatter_add(tgt, idx, src, axis=0):
    return tgt.clone().index_add_(axis, idx, src)
def _segment_sum(src, seg, n):
    out = torch.zeros((n,) + src.shape[1:], dtype=src.dtype)
    return out.index_add_(0, seg, src)
def _pad(x, pw):
    flat = tuple(v for pair in reversed(pw) for v in pair)
    return torch.nn.functional.pad(x, flat)

kernel_name = 'gated_mix__grouped_kv_mqa__grouped_kv_mqa__prompt'

def setup_inputs():

    _w = (lambda a: (lambda t: t.to(torch.bfloat16) if t.is_floating_point() else t)(torch.as_tensor(a)))
    def _A_setup():
        B, S, D, H = 1, 2048, 448, 16
        Dh = D // H
        return {
            "x": _w((lambda *s: torch.randn(*s, dtype=torch.bfloat16) * 0.05)(B, S, D)),
            "wq": _w((lambda *s: torch.randn(*s, dtype=torch.bfloat16) * 0.8)(D, H * Dh)),
            "wk": _w((lambda *s: torch.randn(*s, dtype=torch.bfloat16) * 0.8)(D, Dh)),
            "wv": _w((lambda *s: torch.randn(*s, dtype=torch.bfloat16) * 0.05)(D, Dh)),
            "wo": _w((lambda *s: torch.randn(*s, dtype=torch.bfloat16) * 0.05)(H * Dh, D)),
        }
    _A_in = _A_setup()

    def _B_setup():
        B, S, D, H = 1, 2048, 448, 16
        Dh = D // H
        return {
            "x": _w((lambda *s: torch.randn(*s, dtype=torch.bfloat16) * 0.05)(B, S, D)),
            "wq": _w((lambda *s: torch.randn(*s, dtype=torch.bfloat16) * 0.8)(D, H * Dh)),
            "wk": _w((lambda *s: torch.randn(*s, dtype=torch.bfloat16) * 0.8)(D, Dh)),
            "wv": _w((lambda *s: torch.randn(*s, dtype=torch.bfloat16) * 0.05)(D, Dh)),
            "wo": _w((lambda *s: torch.randn(*s, dtype=torch.bfloat16) * 0.05)(H * Dh, D)),
        }
    _B_in = _B_setup()

    return {
        "A_x": _A_in["x"],
        "A_wq": _A_in["wq"],
        "A_wk": _A_in["wk"],
        "A_wv": _A_in["wv"],
        "A_wo": _A_in["wo"],
        "B_x": _B_in["x"],
        "B_wq": _B_in["wq"],
        "B_wk": _B_in["wk"],
        "B_wv": _B_in["wv"],
        "B_wo": _B_in["wo"],
        "gate_w": _w((lambda *s: torch.randn(*s, dtype=torch.bfloat16) * 0.05)(448) * 16.0),
    }

def reference(A_x, A_wq, A_wk, A_wv, A_wo, B_x, B_wq, B_wk, B_wv, B_wo, gate_w):
    def _A_ref(x, wq, wk, wv, wo):
        B, S, D = x.shape
        H = 16
        Dh = D // H
        q = (lambda x, *d: x.permute(*d))((x @ wq).reshape(B, S, H, Dh), 0, 2, 1, 3)
        k = x @ wk
        v = x @ wv
        scores = torch.einsum("bhqd,bkd->bhqk", q, k) * (Dh ** -0.5)
        p = _softmax(scores, axis=-1)
        o = torch.einsum("bhqk,bkd->bhqd", p, v)
        return (lambda x, *d: x.permute(*d))(o, 0, 2, 1, 3).reshape(B, S, H * Dh) @ wo

    def _B_ref(x, wq, wk, wv, wo):
        B, S, D = x.shape
        H = 16
        Dh = D // H
        q = (lambda x, *d: x.permute(*d))((x @ wq).reshape(B, S, H, Dh), 0, 2, 1, 3)
        k = x @ wk
        v = x @ wv
        scores = torch.einsum("bhqd,bkd->bhqk", q, k) * (Dh ** -0.5)
        p = _softmax(scores, axis=-1)
        o = torch.einsum("bhqk,bkd->bhqd", p, v)
        return (lambda x, *d: x.permute(*d))(o, 0, 2, 1, 3).reshape(B, S, H * Dh) @ wo

    x = A_x
    g = _sigmoid((x * gate_w).sum(-1, keepdims=True))
    a = _A_ref(x, A_wq, A_wk, A_wv, A_wo)
    b = _B_ref(x, B_wq, B_wk, B_wv, B_wo)
    return g * a + (1 - g) * b
```

```asm
; @launch grid=(256,1,1) block=(1024,1,1) lds=163072
.amdgcn_target "amdgcn-amd-amdhsa--gfx950"
.text
.globl gated_mix__grouped_kv_mqa__grouped_kv_mqa__prompt_kernel
.p2align 8
.type gated_mix__grouped_kv_mqa__grouped_kv_mqa__prompt_kernel,@function
gated_mix__grouped_kv_mqa__grouped_kv_mqa__prompt_kernel:
    s_cmp_ge_u32 s2, 256
    s_cbranch_scc1 FA_END
    s_load_dwordx16 s[4:19], s[0:1], 0
    s_load_dwordx8 s[20:27], s[0:1], 64
    s_load_dwordx4 s[28:31], s[0:1], 96
    v_lshrrev_b32 v1, 6, v0
    v_and_b32 v0, 63, v0
    v_readfirstlane_b32 s3, v1
    s_and_b32 s32, s2, 7
    s_lshr_b32 s35, s2, 3
    s_and_b32 s33, s35, 0x18
    s_or_b32 s32, s32, s33
    s_bfe_u32 s33, s35, 0x10002
    s_and_b32 s34, s35, 3
    s_bfe_u32 s35, s32, 0x10002
    s_lshl_b32 s35, s35, 4
    s_lshr_b32 s60, s32, 3
    s_lshl_b32 s60, s60, 2
    s_or_b32 s35, s35, s60
    s_and_b32 s60, s32, 3
    s_or_b32 s35, s35, s60
    v_lshlrev_b32 v1, 4, v0
    v_and_b32 v7, 7, v0
    v_lshlrev_b32 v7, 2, v7
    v_add_u32 v7, 162816, v7
    v_mov_b32 v122, 0
    s_cmp_lt_u32 s3, 8
    s_cbranch_scc1 FA_HI
    v_and_b32 v12, 31, v0
    s_bfe_u32 s60, s3, 0x10002
    s_lshl_b32 s60, s60, 12
    v_lshrrev_b32 v8, 1, v12
    v_and_b32 v8, 7, v8
    v_lshrrev_b32 v9, 5, v0
    v_xor_b32 v8, v8, v9
    v_lshlrev_b32 v9, 7, v12
    v_lshl_add_u32 v8, v8, 4, v9
    v_add_u32 v104, s60, v8
    v_xor_b32 v105, 32, v104
    v_xor_b32 v106, 64, v104
    v_xor_b32 v107, 96, v104
    v_bfe_u32 v8, v0, 2, 2
    v_lshlrev_b32 v8, 1, v8
    v_lshrrev_b32 v9, 5, v0
    v_lshl_add_u32 v8, v9, 3, v8
    v_mul_u32_u24 v8, 224, v8
    v_bfe_u32 v9, v0, 4, 1
    v_lshl_add_u32 v8, v9, 5, v8
    v_and_b32 v9, 3, v0
    v_lshl_add_u32 v8, v9, 3, v8
    s_and_b32 s60, s3, 3
    s_mul_i32 s60, s60, 56
    s_add_u32 s60, s60, 57344
    v_add_u32 v5, s60, v8
    v_add_u32 v6, 57344, v5
    s_and_b32 s60, s3, 7
    s_lshl_b64 s[64:65], 1, s60
    s_waitcnt lgkmcnt(0)
    s_barrier
    v_and_b32 v8, 15, v0
    v_lshrrev_b32 v9, 5, v0
    v_lshl_add_u32 v8, v9, 4, v8
    s_bfe_u32 s62, s3, 0x10002
    s_lshl_b32 s62, s62, 5
    v_add_u32 v8, s62, v8
    v_lshlrev_b32 v8, 4, v8
    v_bfe_u32 v9, v0, 4, 1
    v_lshl_add_u32 v123, v9, 15, v8
    v_lshrrev_b32 v10, 5, v0
    v_bfe_u32 v11, v0, 4, 1
    v_lshlrev_b32 v10, 16, v10
    v_lshl_add_u32 v10, v11, 14, v10
    v_bfe_u32 v11, v0, 2, 2
    v_lshl_add_u32 v10, v11, 12, v10
    v_bfe_u32 v11, v0, 1, 1
    v_lshl_add_u32 v10, v11, 10, v10
    v_and_b32 v11, 1, v0
    v_mul_u32_u24 v11, 528, v11
    v_add_u32 v10, 2060, v10
    v_add_u32 v122, v11, v10
    s_lshr_b32 s7, s3, 3
    s_lshl_b32 s60, s7, 1
    s_and_b32 s61, s3, 1
    s_add_u32 s60, s60, s61
    s_bfe_u32 s61, s3, 0x10001
    s_lshl_b32 s62, s61, 2
    s_add_u32 s62, s62, s60
    s_lshl_b32 s62, s62, 11
    s_add_u32 s62, s62, 98304
    v_add_u32 v15, s62, v1
    s_bfe_u32 s58, s3, 0x10002
    s_lshl_b32 s62, s34, 2
    s_add_u32 s60, s60, s62
    s_lshl_b32 s62, s33, 4
    s_add_u32 s60, s60, s62
    s_lshl_b32 s62, s32, 1
    s_add_u32 s61, s61, s62
    s_lshl_b32 s73, s33, 6
    s_add_u32 s73, s73, s61
    s_lshl_b32 s73, s73, 7
    s_add_u32 s73, s73, 0x480000
    s_lshl_b32 s74, s61, 16
    s_lshl_b32 s62, s60, 10
    s_add_u32 s74, s74, s62
    s_add_u32 s74, s74, 0x500000
    s_lshl_b32 s62, s3, 11
    s_lshl_b32 s72, s33, 18
    s_add_u32 s72, s72, s62
    s_add_u32 s72, s72, 0x400000
    s_mov_b32 s59, 0
    s_mov_b32 s8, 0
    v_and_b32 v117, 7, v0
    v_lshlrev_b32 v117, 2, v117
    v_add_u32 v117, 163008, v117
    v_mov_b32 v119, 1
    s_lshl_b32 s6, s33, 2
    s_add_u32 s6, s6, s34
    v_lshrrev_b32 v8, 3, v0
    v_mul_u32_u24 v8, 896, v8
    v_bfe_u32 v9, v0, 1, 2
    v_lshrrev_b32 v10, 4, v0
    v_xor_b32 v9, v9, v10
    v_lshl_add_u32 v8, v9, 5, v8
    v_and_b32 v9, 1, v0
    v_lshl_add_u32 v8, v9, 4, v8
    s_lshl_b32 s62, s6, 7
    v_add_u32 v118, s62, v8
    s_cmp_eq_u32 s7, 0
    s_cselect_b64 s[40:41], s[12:13], s[22:23]
    s_mov_b32 s42, 0x62000
    s_mov_b32 s43, 0x20000
    s_bfe_u32 s62, s3, 0x20001
    s_and_b32 s63, s3, 1
    s_mul_i32 s63, s63, 3
    s_mul_i32 s4, s62, 100352
    s_mul_i32 s5, s63, 7168
    s_add_u32 s4, s4, s5
    s_lshr_b32 s5, s3, 1
    s_mul_i32 s5, s5, 7
    s_add_u32 s5, s5, s63
    s_lshl_b32 s5, s5, 10
    s_add_u32 s5, s5, 98304
    s_and_b32 s11, s3, 3
    s_bfe_u32 s14, s3, 0x10002
    s_and_b32 s62, s34, 1
    s_xor_b32 s14, s14, s62
    s_lshl_b32 s10, s11, 15
    s_lshl_b32 s62, s14, 14
    s_add_u32 s10, s10, s62
    s_cmp_eq_u32 s7, 0
    s_cselect_b32 s10, s10, 0
    s_lshl_b32 s62, s32, 17
    s_add_u32 s10, s10, s62
    s_add_u32 s10, s10, 0x500000
    s_mul_i32 s15, s14, 53248
    s_sub_u32 s15, s15, 98304
    s_mul_i32 s16, s14, 59392
    s_mul_i32 s17, s14, 0xfffe0400
    s_and_b32 s19, s3, 7
    s_lshl_b32 s18, s19, 10
    s_mul_i32 s19, s19, 7168
    s_add_u32 s19, s19, 50176
    s_mov_b32 s36, s26
    s_mov_b32 s37, s27
    s_mov_b32 s38, 0x1c0000
    s_mov_b32 s39, 0x20000
    s_getreg_b32 s20, hwreg(HW_REG_XCC_ID, 0, 16)
    s_lshl_b32 s62, s33, 14
    s_add_u32 s62, s62, 0x900000
    s_and_b32 s63, s2, 7
    s_mul_i32 s63, s63, 0x8000
    s_add_u32 s62, s62, s63
    v_lshl_add_u32 v116, v0, 9, s62
    s_lshl_b32 s62, s58, 14
    v_add_u32 v2, s62, v1
    v_add_u32 v3, 0x10000, v2
    v_mov_b32 v4, 0xdddd
    s_mov_b32 s75, 0x40000
FA_SP1:
    ds_read_b32 v124, v7 offset:0
    s_waitcnt lgkmcnt(0)
    v_cmp_le_u32 vcc, 1, v124
    s_sub_u32 s75, s75, 1
    s_cbranch_scc1 FA_SX1
    s_cmp_eq_u64 vcc, -1
    s_cbranch_scc0 FA_SP1
FA_SX1:
    ds_read_b64_tr_b16 v[24:25], v5 offset:28672
    ds_read_b64_tr_b16 v[26:27], v5 offset:28896
    ds_read_b128 v[40:43], v104 offset:0
    ds_read_b64_tr_b16 v[28:29], v5 offset:32256
    ds_read_b64_tr_b16 v[30:31], v5 offset:32480
    ds_read_b128 v[44:47], v105 offset:0
    ds_read_b64_tr_b16 v[32:33], v5 offset:35840
    ds_read_b64_tr_b16 v[34:35], v5 offset:36064
    ds_read_b128 v[48:51], v106 offset:0
    ds_read_b64_tr_b16 v[36:37], v5 offset:39424
    ds_read_b64_tr_b16 v[38:39], v5 offset:39648
    ds_read_b128 v[52:55], v107 offset:0
    ds_read_b32 v124, v7 offset:0
    s_waitcnt lgkmcnt(1)
    v_mfma_f32_32x32x16_bf16 v[88:103], v[24:27], v[40:43], 0
    v_mfma_f32_32x32x16_bf16 v[88:103], v[28:31], v[44:47], v[88:103]
    v_mfma_f32_32x32x16_bf16 v[88:103], v[32:35], v[48:51], v[88:103]
    v_mfma_f32_32x32x16_bf16 v[88:103], v[36:39], v[52:55], v[88:103]
    s_waitcnt lgkmcnt(0)
    v_cmp_le_u32 vcc, 2, v124
    s_cmp_eq_u64 vcc, -1
    s_cbranch_scc1 FA_QOK0
    s_mov_b32 s75, 0x40000
FA_SP2:
    ds_read_b32 v124, v7 offset:0
    s_waitcnt lgkmcnt(0)
    v_cmp_le_u32 vcc, 2, v124
    s_sub_u32 s75, s75, 1
    s_cbranch_scc1 FA_SX2
    s_cmp_eq_u64 vcc, -1
    s_cbranch_scc0 FA_SP2
FA_SX2:
FA_QOK0:
    ds_read_b64_tr_b16 v[56:57], v5 offset:43008
    ds_read_b64_tr_b16 v[58:59], v5 offset:43232
    ds_read_b128 v[72:75], v104 offset:8192
    ds_read_b64_tr_b16 v[60:61], v5 offset:46592
    ds_read_b64_tr_b16 v[62:63], v5 offset:46816
    ds_read_b128 v[76:79], v105 offset:8192
    ds_read_b64_tr_b16 v[64:65], v5 offset:50176
    ds_read_b64_tr_b16 v[66:67], v5 offset:50400
    ds_read_b128 v[80:83], v106 offset:8192
    ds_read_b64_tr_b16 v[68:69], v5 offset:53760
    ds_read_b64_tr_b16 v[70:71], v5 offset:53984
    ds_read_b128 v[84:87], v107 offset:8192
    ds_read_b32 v124, v7 offset:0
    s_waitcnt lgkmcnt(1)
    v_mfma_f32_32x32x16_bf16 v[88:103], v[56:59], v[72:75], v[88:103]
    v_mfma_f32_32x32x16_bf16 v[88:103], v[60:63], v[76:79], v[88:103]
    v_mfma_f32_32x32x16_bf16 v[88:103], v[64:67], v[80:83], v[88:103]
    v_mfma_f32_32x32x16_bf16 v[88:103], v[68:71], v[84:87], v[88:103]
    s_waitcnt lgkmcnt(0)
    v_cmp_le_u32 vcc, 3, v124
    s_cmp_eq_u64 vcc, -1
    s_cbranch_scc1 FA_QOK1
    s_mov_b32 s75, 0x40000
FA_SP3:
    ds_read_b32 v124, v7 offset:0
    s_waitcnt lgkmcnt(0)
    v_cmp_le_u32 vcc, 3, v124
    s_sub_u32 s75, s75, 1
    s_cbranch_scc1 FA_SX3
    s_cmp_eq_u64 vcc, -1
    s_cbranch_scc0 FA_SP3
FA_SX3:
FA_QOK1:
    ds_read_b64_tr_b16 v[24:25], v6 offset:0
    ds_read_b64_tr_b16 v[26:27], v6 offset:224
    ds_read_b128 v[40:43], v104 offset:16384
    ds_read_b64_tr_b16 v[28:29], v6 offset:3584
    ds_read_b64_tr_b16 v[30:31], v6 offset:3808
    ds_read_b128 v[44:47], v105 offset:16384
    ds_read_b64_tr_b16 v[32:33], v6 offset:7168
    ds_read_b64_tr_b16 v[34:35], v6 offset:7392
    ds_read_b128 v[48:51], v106 offset:16384
    ds_read_b64_tr_b16 v[36:37], v6 offset:10752
    ds_read_b64_tr_b16 v[38:39], v6 offset:10976
    ds_read_b128 v[52:55], v107 offset:16384
    ds_read_b32 v124, v7 offset:0
    s_waitcnt lgkmcnt(1)
    v_mfma_f32_32x32x16_bf16 v[88:103], v[24:27], v[40:43], v[88:103]
    v_mfma_f32_32x32x16_bf16 v[88:103], v[28:31], v[44:47], v[88:103]
    v_mfma_f32_32x32x16_bf16 v[88:103], v[32:35], v[48:51], v[88:103]
    v_mfma_f32_32x32x16_bf16 v[88:103], v[36:39], v[52:55], v[88:103]
    s_waitcnt lgkmcnt(0)
    v_cmp_le_u32 vcc, 4, v124
    s_cmp_eq_u64 vcc, -1
    s_cbranch_scc1 FA_QOK2
    s_mov_b32 s75, 0x40000
FA_SP4:
    ds_read_b32 v124, v7 offset:0
    s_waitcnt lgkmcnt(0)
    v_cmp_le_u32 vcc, 4, v124
    s_sub_u32 s75, s75, 1
    s_cbranch_scc1 FA_SX4
    s_cmp_eq_u64 vcc, -1
    s_cbranch_scc0 FA_SP4
FA_SX4:
FA_QOK2:
    ds_read_b64_tr_b16 v[56:57], v6 offset:14336
    ds_read_b64_tr_b16 v[58:59], v6 offset:14560
    ds_read_b128 v[72:75], v104 offset:24576
    ds_read_b64_tr_b16 v[60:61], v6 offset:17920
    ds_read_b64_tr_b16 v[62:63], v6 offset:18144
    ds_read_b128 v[76:79], v105 offset:24576
    ds_read_b64_tr_b16 v[64:65], v6 offset:21504
    ds_read_b64_tr_b16 v[66:67], v6 offset:21728
    ds_read_b128 v[80:83], v106 offset:24576
    ds_read_b64_tr_b16 v[68:69], v6 offset:25088
    ds_read_b64_tr_b16 v[70:71], v6 offset:25312
    ds_read_b128 v[84:87], v107 offset:24576
    ds_read_b32 v124, v7 offset:0
    s_waitcnt lgkmcnt(1)
    s_mov_b64 exec, s[64:65]
    v_mov_b32 v125, 1
    ds_write_b32 v7, v125 offset:32
    s_mov_b64 exec, -1
    v_mfma_f32_32x32x16_bf16 v[88:103], v[56:59], v[72:75], v[88:103]
    v_mfma_f32_32x32x16_bf16 v[88:103], v[60:63], v[76:79], v[88:103]
    v_mfma_f32_32x32x16_bf16 v[88:103], v[64:67], v[80:83], v[88:103]
    v_mfma_f32_32x32x16_bf16 v[88:103], v[68:71], v[84:87], v[88:103]
    s_waitcnt lgkmcnt(0)
    v_cmp_le_u32 vcc, 5, v124
    s_cmp_eq_u64 vcc, -1
    s_cbranch_scc1 FA_QOK3
    s_mov_b32 s75, 0x40000
FA_SP5:
    ds_read_b32 v124, v7 offset:0
    s_waitcnt lgkmcnt(0)
    v_cmp_le_u32 vcc, 5, v124
    s_sub_u32 s75, s75, 1
    s_cbranch_scc1 FA_SX5
    s_cmp_eq_u64 vcc, -1
    s_cbranch_scc0 FA_SP5
FA_SX5:
FA_QOK3:
    ds_read_b64_tr_b16 v[24:25], v6 offset:28672
    ds_read_b64_tr_b16 v[26:27], v6 offset:28896
    ds_read_b128 v[40:43], v104 offset:32768
    ds_read_b64_tr_b16 v[28:29], v6 offset:32256
    ds_read_b64_tr_b16 v[30:31], v6 offset:32480
    ds_read_b128 v[44:47], v105 offset:32768
    ds_read_b64_tr_b16 v[32:33], v6 offset:35840
    ds_read_b64_tr_b16 v[34:35], v6 offset:36064
    ds_read_b128 v[48:51], v106 offset:32768
    ds_read_b64_tr_b16 v[36:37], v6 offset:39424
    ds_read_b64_tr_b16 v[38:39], v6 offset:39648
    ds_read_b128 v[52:55], v107 offset:32768
    ds_read_b32 v124, v7 offset:0
    s_waitcnt lgkmcnt(1)
    v_mfma_f32_32x32x16_bf16 v[88:103], v[24:27], v[40:43], v[88:103]
    v_mfma_f32_32x32x16_bf16 v[88:103], v[28:31], v[44:47], v[88:103]
    v_mfma_f32_32x32x16_bf16 v[88:103], v[32:35], v[48:51], v[88:103]
    v_mfma_f32_32x32x16_bf16 v[88:103], v[36:39], v[52:55], v[88:103]
    s_waitcnt lgkmcnt(0)
    v_cmp_le_u32 vcc, 6, v124
    s_cmp_eq_u64 vcc, -1
    s_cbranch_scc1 FA_QOK4
    s_mov_b32 s75, 0x40000
FA_SP6:
    ds_read_b32 v124, v7 offset:0
    s_waitcnt lgkmcnt(0)
    v_cmp_le_u32 vcc, 6, v124
    s_sub_u32 s75, s75, 1
    s_cbranch_scc1 FA_SX6
    s_cmp_eq_u64 vcc, -1
    s_cbranch_scc0 FA_SP6
FA_SX6:
FA_QOK4:
    ds_read_b64_tr_b16 v[56:57], v5 offset:0
    ds_read_b64_tr_b16 v[58:59], v5 offset:224
    ds_read_b128 v[72:75], v104 offset:40960
    ds_read_b64_tr_b16 v[60:61], v5 offset:3584
    ds_read_b64_tr_b16 v[62:63], v5 offset:3808
    ds_read_b128 v[76:79], v105 offset:40960
    ds_read_b64_tr_b16 v[64:65], v5 offset:7168
    ds_read_b64_tr_b16 v[66:67], v5 offset:7392
    ds_read_b128 v[80:83], v106 offset:40960
    ds_read_b64_tr_b16 v[68:69], v5 offset:10752
    ds_read_b64_tr_b16 v[70:71], v5 offset:10976
    ds_read_b128 v[84:87], v107 offset:40960
    ds_read_b32 v124, v7 offset:0
    s_waitcnt lgkmcnt(1)
    v_mfma_f32_32x32x16_bf16 v[88:103], v[56:59], v[72:75], v[88:103]
    v_mfma_f32_32x32x16_bf16 v[88:103], v[60:63], v[76:79], v[88:103]
    v_mfma_f32_32x32x16_bf16 v[88:103], v[64:67], v[80:83], v[88:103]
    v_mfma_f32_32x32x16_bf16 v[88:103], v[68:71], v[84:87], v[88:103]
    s_waitcnt lgkmcnt(0)
    v_cmp_le_u32 vcc, 7, v124
    s_cmp_eq_u64 vcc, -1
    s_cbranch_scc1 FA_QOK5
    s_mov_b32 s75, 0x40000
FA_SP7:
    ds_read_b32 v124, v7 offset:0
    s_waitcnt lgkmcnt(0)
    v_cmp_le_u32 vcc, 7, v124
    s_sub_u32 s75, s75, 1
    s_cbranch_scc1 FA_SX7
    s_cmp_eq_u64 vcc, -1
    s_cbranch_scc0 FA_SP7
FA_SX7:
FA_QOK5:
    ds_read_b64_tr_b16 v[24:25], v5 offset:14336
    ds_read_b64_tr_b16 v[26:27], v5 offset:14560
    ds_read_b128 v[40:43], v104 offset:49152
    ds_read_b64_tr_b16 v[28:29], v5 offset:17920
    ds_read_b64_tr_b16 v[30:31], v5 offset:18144
    ds_read_b128 v[44:47], v105 offset:49152
    ds_read_b64_tr_b16 v[32:33], v5 offset:21504
    ds_read_b64_tr_b16 v[34:35], v5 offset:21728
    ds_read_b128 v[48:51], v106 offset:49152
    ds_read_b64_tr_b16 v[36:37], v5 offset:25088
    ds_read_b64_tr_b16 v[38:39], v5 offset:25312
    ds_read_b128 v[52:55], v107 offset:49152
    s_waitcnt lgkmcnt(0)
    v_mfma_f32_32x32x16_bf16 v[88:103], v[24:27], v[40:43], v[88:103]
    v_mfma_f32_32x32x16_bf16 v[88:103], v[28:31], v[44:47], v[88:103]
    v_mfma_f32_32x32x16_bf16 v[88:103], v[32:35], v[48:51], v[88:103]
    v_mfma_f32_32x32x16_bf16 v[88:103], v[36:39], v[52:55], v[88:103]
    s_mov_b32 s60, 0x3e8b97f6
    s_lshl_b32 s61, s3, 11
    s_add_u32 s61, s61, 81920
    v_add_u32 v8, s61, v1
    s_mov_b32 s44, s30
    s_mov_b32 s45, s31
    s_mov_b32 s46, 0x1000000
    s_mov_b32 s47, 0x20000
    s_mov_b32 s57, -1
    s_nop 1
    ds_read_b32 v124, v7 offset:32
    s_nop 2
    v_mul_f32 v88, s60, v88
    v_mul_f32 v89, s60, v89
    v_mul_f32 v90, s60, v90
    v_mul_f32 v91, s60, v91
    v_mul_f32 v92, s60, v92
    v_mul_f32 v93, s60, v93
    v_mul_f32 v94, s60, v94
    v_mul_f32 v95, s60, v95
    v_mul_f32 v96, s60, v96
    v_mul_f32 v97, s60, v97
    v_mul_f32 v98, s60, v98
    v_mul_f32 v99, s60, v99
    v_mul_f32 v100, s60, v100
    v_mul_f32 v101, s60, v101
    v_mul_f32 v102, s60, v102
    v_mul_f32 v103, s60, v103
    v_cvt_pk_bf16_f32 v16, v88, v89
    v_cvt_pk_bf16_f32 v17, v90, v91
    v_cvt_pk_bf16_f32 v18, v92, v93
    v_cvt_pk_bf16_f32 v19, v94, v95
    v_cvt_pk_bf16_f32 v20, v96, v97
    v_cvt_pk_bf16_f32 v21, v98, v99
    v_cvt_pk_bf16_f32 v22, v100, v101
    v_cvt_pk_bf16_f32 v23, v102, v103
    s_mov_b32 exec_lo, 0
    v_mov_b32 v22, 0
    v_mov_b32 v23, 0
    s_mov_b32 exec_lo, -1
    s_waitcnt lgkmcnt(0)
    v_cmp_le_u32 vcc, 1, v124
    s_cmp_eq_u64 vcc, -1
    s_cbranch_scc1 FA_QPOK
    s_mov_b32 s75, 0x40000
FA_SP8:
    ds_read_b32 v124, v7 offset:32
    s_waitcnt lgkmcnt(0)
    v_cmp_le_u32 vcc, 1, v124
    s_sub_u32 s75, s75, 1
    s_cbranch_scc1 FA_SX8
    s_cmp_eq_u64 vcc, -1
    s_cbranch_scc0 FA_SP8
FA_SX8:
FA_QPOK:
    ds_write_b128 v8, v[16:19]
    ds_write_b128 v8, v[20:23] offset:1024
    s_waitcnt lgkmcnt(0)
    s_branch FA_XY
FA_HI:
    s_cmp_lt_u32 s3, 3
    s_cbranch_scc1 FA_HI2
    s_cmp_eq_u32 s3, 3
    s_cbranch_scc1 FA_XO
    s_sub_u32 s54, s3, 4
    s_mul_i32 s63, s34, 224
    s_lshl_b32 s60, s54, 6
    v_add_u32 v8, s60, v0
    v_mul_u32_u24 v9, 4682, v8
    v_lshrrev_b32 v9, 16, v9
    v_mul_u32_u24 v10, 14, v9
    v_sub_u32 v8, v8, v10
    v_bfe_u32 v10, v9, 1, 2
    v_and_b32 v11, 1, v9
    v_lshl_add_u32 v10, v11, 2, v10
    v_and_b32 v9, 56, v9
    v_add_u32 v9, v9, v10
    v_mul_u32_u24 v9, 896, v9
    v_lshl_add_u32 v9, v8, 4, v9
    v_add_u32 v108, s63, v9
    s_lshl_b32 s60, s54, 6
    s_add_u32 s60, s60, 256
    v_add_u32 v8, s60, v0
    v_mul_u32_u24 v9, 4682, v8
    v_lshrrev_b32 v9, 16, v9
    v_mul_u32_u24 v10, 14, v9
    v_sub_u32 v8, v8, v10
    v_bfe_u32 v10, v9, 1, 2
    v_and_b32 v11, 1, v9
    v_lshl_add_u32 v10, v11, 2, v10
    v_and_b32 v9, 56, v9
    v_add_u32 v9, v9, v10
    v_mul_u32_u24 v9, 896, v9
    v_lshl_add_u32 v9, v8, 4, v9
    v_add_u32 v109, s63, v9
    s_lshl_b32 s60, s54, 6
    s_add_u32 s60, s60, 512
    v_add_u32 v8, s60, v0
    v_mul_u32_u24 v9, 4682, v8
    v_lshrrev_b32 v9, 16, v9
    v_mul_u32_u24 v10, 14, v9
    v_sub_u32 v8, v8, v10
    v_bfe_u32 v10, v9, 1, 2
    v_and_b32 v11, 1, v9
    v_lshl_add_u32 v10, v11, 2, v10
    v_and_b32 v9, 56, v9
    v_add_u32 v9, v9, v10
    v_mul_u32_u24 v9, 896, v9
    v_lshl_add_u32 v9, v8, 4, v9
    v_add_u32 v110, s63, v9
    s_lshl_b32 s60, s54, 6
    s_add_u32 s60, s60, 768
    v_add_u32 v8, s60, v0
    v_mul_u32_u24 v9, 4682, v8
    v_lshrrev_b32 v9, 16, v9
    v_mul_u32_u24 v10, 14, v9
    v_sub_u32 v8, v8, v10
    v_bfe_u32 v10, v9, 1, 2
    v_and_b32 v11, 1, v9
    v_lshl_add_u32 v10, v11, 2, v10
    v_and_b32 v9, 56, v9
    v_add_u32 v9, v9, v10
    v_mul_u32_u24 v9, 896, v9
    v_lshl_add_u32 v9, v8, 4, v9
    v_add_u32 v111, s63, v9
    s_add_u32 s60, s54, 3
    s_lshl_b64 s[64:65], 1, s60
    s_lshl_b32 s52, s54, 10
    s_waitcnt lgkmcnt(0)
    s_cmp_eq_u32 s33, 0
    s_cselect_b64 s[48:49], s[6:7], s[16:17]
    s_mov_b32 s50, 0x62000
    s_mov_b32 s51, 0x20000
    s_mov_b32 s44, s30
    s_mov_b32 s45, s31
    s_mov_b32 s46, 0x1000000
    s_mov_b32 s47, 0x20000
    s_cmp_ge_u32 s3, 6
    s_cbranch_scc1 FA_WQ3
    s_cmp_lt_u32 s35, 8
    s_cbranch_scc0 FA_PB9
    s_barrier
FA_PB9:
    s_add_u32 m0, s52, 86016
    s_mov_b32 s53, 0
    buffer_load_dwordx4 v108, s[48:51], s53 offen lds
    s_add_u32 m0, s52, 90112
    s_mov_b32 s53, 0
    buffer_load_dwordx4 v109, s[48:51], s53 offen lds
    s_add_u32 m0, s52, 94208
    s_mov_b32 s53, 0
    buffer_load_dwordx4 v110, s[48:51], s53 offen lds
    s_add_u32 m0, s52, 98304
    s_mov_b32 s53, 0
    buffer_load_dwordx4 v111, s[48:51], s53 offen lds
    s_lshr_b32 s7, s3, 3
    s_lshl_b32 s60, s7, 1
    s_and_b32 s61, s3, 1
    s_add_u32 s60, s60, s61
    s_bfe_u32 s61, s3, 0x10001
    s_lshl_b32 s62, s61, 2
    s_add_u32 s62, s62, s60
    s_lshl_b32 s62, s62, 11
    s_add_u32 s62, s62, 98304
    v_add_u32 v15, s62, v1
    s_bfe_u32 s58, s3, 0x10002
    s_lshl_b32 s62, s34, 2
    s_add_u32 s60, s60, s62
    s_lshl_b32 s62, s33, 4
    s_add_u32 s60, s60, s62
    s_lshl_b32 s62, s32, 1
    s_add_u32 s61, s61, s62
    s_lshl_b32 s73, s33, 6
    s_add_u32 s73, s73, s61
    s_lshl_b32 s73, s73, 7
    s_add_u32 s73, s73, 0x480000
    s_lshl_b32 s74, s61, 16
    s_lshl_b32 s62, s60, 10
    s_add_u32 s74, s74, s62
    s_add_u32 s74, s74, 0x500000
    s_lshl_b32 s62, s3, 11
    s_lshl_b32 s72, s33, 18
    s_add_u32 s72, s72, s62
    s_add_u32 s72, s72, 0x400000
    s_mov_b32 s59, 0
    s_mov_b32 s8, 0
    v_and_b32 v117, 7, v0
    v_lshlrev_b32 v117, 2, v117
    v_add_u32 v117, 163008, v117
    v_mov_b32 v119, 1
    s_lshl_b32 s6, s33, 2
    s_add_u32 s6, s6, s34
    v_lshrrev_b32 v8, 3, v0
    v_mul_u32_u24 v8, 896, v8
    v_bfe_u32 v9, v0, 1, 2
    v_lshrrev_b32 v10, 4, v0
    v_xor_b32 v9, v9, v10
    v_lshl_add_u32 v8, v9, 5, v8
    v_and_b32 v9, 1, v0
    v_lshl_add_u32 v8, v9, 4, v8
    s_lshl_b32 s62, s6, 7
    v_add_u32 v118, s62, v8
    s_cmp_eq_u32 s7, 0
    s_cselect_b64 s[40:41], s[12:13], s[22:23]
    s_mov_b32 s42, 0x62000
    s_mov_b32 s43, 0x20000
    s_bfe_u32 s62, s3, 0x20001
    s_and_b32 s63, s3, 1
    s_mul_i32 s63, s63, 3
    s_mul_i32 s4, s62, 100352
    s_mul_i32 s5, s63, 7168
    s_add_u32 s4, s4, s5
    s_lshr_b32 s5, s3, 1
    s_mul_i32 s5, s5, 7
    s_add_u32 s5, s5, s63
    s_lshl_b32 s5, s5, 10
    s_add_u32 s5, s5, 98304
    s_and_b32 s11, s3, 3
    s_bfe_u32 s14, s3, 0x10002
    s_and_b32 s62, s34, 1
    s_xor_b32 s14, s14, s62
    s_lshl_b32 s10, s11, 15
    s_lshl_b32 s62, s14, 14
    s_add_u32 s10, s10, s62
    s_cmp_eq_u32 s7, 0
    s_cselect_b32 s10, s10, 0
    s_lshl_b32 s62, s32, 17
    s_add_u32 s10, s10, s62
    s_add_u32 s10, s10, 0x500000
    s_mul_i32 s15, s14, 53248
    s_sub_u32 s15, s15, 98304
    s_mul_i32 s16, s14, 59392
    s_mul_i32 s17, s14, 0xfffe0400
    s_and_b32 s19, s3, 7
    s_lshl_b32 s18, s19, 10
    s_mul_i32 s19, s19, 7168
    s_add_u32 s19, s19, 50176
    s_mov_b32 s36, s26
    s_mov_b32 s37, s27
    s_mov_b32 s38, 0x1c0000
    s_mov_b32 s39, 0x20000
    s_getreg_b32 s20, hwreg(HW_REG_XCC_ID, 0, 16)
    s_lshl_b32 s62, s33, 14
    s_add_u32 s62, s62, 0x900000
    s_and_b32 s63, s2, 7
    s_mul_i32 s63, s63, 0x8000
    s_add_u32 s62, s62, s63
    v_lshl_add_u32 v116, v0, 9, s62
    s_lshl_b32 s62, s58, 14
    v_add_u32 v2, s62, v1
    v_add_u32 v3, 0x10000, v2
    v_mov_b32 v4, 0xdddd
    s_cmp_lt_u32 s35, 8
    s_cbranch_scc1 FA_PB10
    s_barrier
FA_PB10:
    s_waitcnt vmcnt(3)
    s_add_u32 m0, s52, 100352
    s_mov_b32 s53, 57344
    buffer_load_dwordx4 v108, s[48:51], s53 offen lds
    s_waitcnt vmcnt(3)
    s_add_u32 m0, s52, 104448
    s_mov_b32 s53, 57344
    buffer_load_dwordx4 v109, s[48:51], s53 offen lds
    s_waitcnt vmcnt(3)
    s_add_u32 m0, s52, 108544
    s_mov_b32 s53, 57344
    buffer_load_dwordx4 v110, s[48:51], s53 offen lds
    s_waitcnt vmcnt(3)
    s_mov_b64 exec, s[64:65]
    v_mov_b32 v125, 1
    ds_write_b32 v7, v125 offset:0
    s_mov_b64 exec, -1
    s_add_u32 m0, s52, 112640
    s_mov_b32 s53, 57344
    buffer_load_dwordx4 v111, s[48:51], s53 offen lds
    s_waitcnt vmcnt(3)
    s_add_u32 m0, s52, 114688
    s_mov_b32 s53, 114688
    buffer_load_dwordx4 v108, s[48:51], s53 offen lds
    s_waitcnt vmcnt(3)
    s_add_u32 m0, s52, 118784
    s_mov_b32 s53, 114688
    buffer_load_dwordx4 v109, s[48:51], s53 offen lds
    s_waitcnt vmcnt(3)
    s_add_u32 m0, s52, 122880
    s_mov_b32 s53, 114688
    buffer_load_dwordx4 v110, s[48:51], s53 offen lds
    s_waitcnt vmcnt(3)
    s_mov_b64 exec, s[64:65]
    v_mov_b32 v125, 2
    ds_write_b32 v7, v125 offset:0
    s_mov_b64 exec, -1
    s_add_u32 m0, s52, 126976
    s_mov_b32 s53, 114688
    buffer_load_dwordx4 v111, s[48:51], s53 offen lds
    s_waitcnt vmcnt(3)
    s_add_u32 m0, s52, 129024
    s_mov_b32 s53, 172032
    buffer_load_dwordx4 v108, s[48:51], s53 offen lds
    s_waitcnt vmcnt(3)
    s_add_u32 m0, s52, 133120
    s_mov_b32 s53, 172032
    buffer_load_dwordx4 v109, s[48:51], s53 offen lds
    s_waitcnt vmcnt(3)
    s_add_u32 m0, s52, 137216
    s_mov_b32 s53, 172032
    buffer_load_dwordx4 v110, s[48:51], s53 offen lds
    s_waitcnt vmcnt(3)
    s_mov_b64 exec, s[64:65]
    v_mov_b32 v125, 3
    ds_write_b32 v7, v125 offset:0
    s_mov_b64 exec, -1
    s_add_u32 m0, s52, 141312
    s_mov_b32 s53, 172032
    buffer_load_dwordx4 v111, s[48:51], s53 offen lds
    s_waitcnt vmcnt(3)
    s_add_u32 m0, s52, 143360
    s_mov_b32 s53, 229376
    buffer_load_dwordx4 v108, s[48:51], s53 offen lds
    s_waitcnt vmcnt(3)
    s_add_u32 m0, s52, 147456
    s_mov_b32 s53, 229376
    buffer_load_dwordx4 v109, s[48:51], s53 offen lds
    s_waitcnt vmcnt(3)
    s_add_u32 m0, s52, 151552
    s_mov_b32 s53, 229376
    buffer_load_dwordx4 v110, s[48:51], s53 offen lds
    s_waitcnt vmcnt(3)
    s_mov_b64 exec, s[64:65]
    v_mov_b32 v125, 4
    ds_write_b32 v7, v125 offset:0
    s_mov_b64 exec, -1
    s_add_u32 m0, s52, 155648
    s_mov_b32 s53, 229376
    buffer_load_dwordx4 v111, s[48:51], s53 offen lds
    s_waitcnt vmcnt(3)
    s_mov_b32 s75, 0x40000
FA_SP11:
    ds_read_b32 v124, v7 offset:64
    s_waitcnt lgkmcnt(0)
    v_cmp_le_u32 vcc, 1, v124
    s_sub_u32 s75, s75, 1
    s_cbranch_scc1 FA_SX11
    s_and_b32 s70, vcc_lo, 0xc
    s_cmp_eq_u32 s70, 0xc
    s_cbranch_scc0 FA_SP11
FA_SX11:
    s_add_u32 m0, s52, 57344
    s_mov_b32 s53, 286720
    buffer_load_dwordx4 v108, s[48:51], s53 offen lds
    s_waitcnt vmcnt(3)
    s_add_u32 m0, s52, 61440
    s_mov_b32 s53, 286720
    buffer_load_dwordx4 v109, s[48:51], s53 offen lds
    s_waitcnt vmcnt(3)
    s_add_u32 m0, s52, 65536
    s_mov_b32 s53, 286720
    buffer_load_dwordx4 v110, s[48:51], s53 offen lds
    s_waitcnt vmcnt(3)
    s_mov_b64 exec, s[64:65]
    v_mov_b32 v125, 5
    ds_write_b32 v7, v125 offset:0
    s_mov_b64 exec, -1
    s_add_u32 m0, s52, 69632
    s_mov_b32 s53, 286720
    buffer_load_dwordx4 v111, s[48:51], s53 offen lds
    s_waitcnt vmcnt(3)
    s_add_u32 m0, s52, 71680
    s_mov_b32 s53, 344064
    buffer_load_dwordx4 v108, s[48:51], s53 offen lds
    s_waitcnt vmcnt(3)
    s_add_u32 m0, s52, 75776
    s_mov_b32 s53, 344064
    buffer_load_dwordx4 v109, s[48:51], s53 offen lds
    s_waitcnt vmcnt(3)
    s_add_u32 m0, s52, 79872
    s_mov_b32 s53, 344064
    buffer_load_dwordx4 v110, s[48:51], s53 offen lds
    s_waitcnt vmcnt(3)
    s_mov_b64 exec, s[64:65]
    v_mov_b32 v125, 6
    ds_write_b32 v7, v125 offset:0
    s_mov_b64 exec, -1
    s_add_u32 m0, s52, 83968
    s_mov_b32 s53, 344064
    buffer_load_dwordx4 v111, s[48:51], s53 offen lds
    s_waitcnt vmcnt(0)
    s_mov_b64 exec, s[64:65]
    v_mov_b32 v125, 7
    ds_write_b32 v7, v125 offset:0
    s_mov_b64 exec, -1
    s_branch FA_P0
FA_WQ3:
    s_cmp_lt_u32 s35, 8
    s_cbranch_scc0 FA_PB12
    s_barrier
FA_PB12:
    s_add_u32 m0, s52, 86016
    s_mov_b32 s53, 0
    buffer_load_dwordx4 v108, s[48:51], s53 offen lds
    s_add_u32 m0, s52, 90112
    s_mov_b32 s53, 0
    buffer_load_dwordx4 v109, s[48:51], s53 offen lds
    s_add_u32 m0, s52, 94208
    s_mov_b32 s53, 0
    buffer_load_dwordx4 v110, s[48:51], s53 offen lds
    s_add_u32 m0, s52, 100352
    s_mov_b32 s53, 57344
    buffer_load_dwordx4 v108, s[48:51], s53 offen lds
    s_lshr_b32 s7, s3, 3
    s_lshl_b32 s60, s7, 1
    s_and_b32 s61, s3, 1
    s_add_u32 s60, s60, s61
    s_bfe_u32 s61, s3, 0x10001
    s_lshl_b32 s62, s61, 2
    s_add_u32 s62, s62, s60
    s_lshl_b32 s62, s62, 11
    s_add_u32 s62, s62, 98304
    v_add_u32 v15, s62, v1
    s_bfe_u32 s58, s3, 0x10002
    s_lshl_b32 s62, s34, 2
    s_add_u32 s60, s60, s62
    s_lshl_b32 s62, s33, 4
    s_add_u32 s60, s60, s62
    s_lshl_b32 s62, s32, 1
    s_add_u32 s61, s61, s62
    s_lshl_b32 s73, s33, 6
    s_add_u32 s73, s73, s61
    s_lshl_b32 s73, s73, 7
    s_add_u32 s73, s73, 0x480000
    s_lshl_b32 s74, s61, 16
    s_lshl_b32 s62, s60, 10
    s_add_u32 s74, s74, s62
    s_add_u32 s74, s74, 0x500000
    s_lshl_b32 s62, s3, 11
    s_lshl_b32 s72, s33, 18
    s_add_u32 s72, s72, s62
    s_add_u32 s72, s72, 0x400000
    s_mov_b32 s59, 0
    s_mov_b32 s8, 0
    v_and_b32 v117, 7, v0
    v_lshlrev_b32 v117, 2, v117
    v_add_u32 v117, 163008, v117
    v_mov_b32 v119, 1
    s_lshl_b32 s6, s33, 2
    s_add_u32 s6, s6, s34
    v_lshrrev_b32 v8, 3, v0
    v_mul_u32_u24 v8, 896, v8
    v_bfe_u32 v9, v0, 1, 2
    v_lshrrev_b32 v10, 4, v0
    v_xor_b32 v9, v9, v10
    v_lshl_add_u32 v8, v9, 5, v8
    v_and_b32 v9, 1, v0
    v_lshl_add_u32 v8, v9, 4, v8
    s_lshl_b32 s62, s6, 7
    v_add_u32 v118, s62, v8
    s_cmp_eq_u32 s7, 0
    s_cselect_b64 s[40:41], s[12:13], s[22:23]
    s_mov_b32 s42, 0x62000
    s_mov_b32 s43, 0x20000
    s_bfe_u32 s62, s3, 0x20001
    s_and_b32 s63, s3, 1
    s_mul_i32 s63, s63, 3
    s_mul_i32 s4, s62, 100352
    s_mul_i32 s5, s63, 7168
    s_add_u32 s4, s4, s5
    s_lshr_b32 s5, s3, 1
    s_mul_i32 s5, s5, 7
    s_add_u32 s5, s5, s63
    s_lshl_b32 s5, s5, 10
    s_add_u32 s5, s5, 98304
    s_and_b32 s11, s3, 3
    s_bfe_u32 s14, s3, 0x10002
    s_and_b32 s62, s34, 1
    s_xor_b32 s14, s14, s62
    s_lshl_b32 s10, s11, 15
    s_lshl_b32 s62, s14, 14
    s_add_u32 s10, s10, s62
    s_cmp_eq_u32 s7, 0
    s_cselect_b32 s10, s10, 0
    s_lshl_b32 s62, s32, 17
    s_add_u32 s10, s10, s62
    s_add_u32 s10, s10, 0x500000
    s_mul_i32 s15, s14, 53248
    s_sub_u32 s15, s15, 98304
    s_mul_i32 s16, s14, 59392
    s_mul_i32 s17, s14, 0xfffe0400
    s_and_b32 s19, s3, 7
    s_lshl_b32 s18, s19, 10
    s_mul_i32 s19, s19, 7168
    s_add_u32 s19, s19, 50176
    s_mov_b32 s36, s26
    s_mov_b32 s37, s27
    s_mov_b32 s38, 0x1c0000
    s_mov_b32 s39, 0x20000
    s_getreg_b32 s20, hwreg(HW_REG_XCC_ID, 0, 16)
    s_lshl_b32 s62, s33, 14
    s_add_u32 s62, s62, 0x900000
    s_and_b32 s63, s2, 7
    s_mul_i32 s63, s63, 0x8000
    s_add_u32 s62, s62, s63
    v_lshl_add_u32 v116, v0, 9, s62
    s_lshl_b32 s62, s58, 14
    v_add_u32 v2, s62, v1
    v_add_u32 v3, 0x10000, v2
    v_mov_b32 v4, 0xdddd
    s_cmp_lt_u32 s35, 8
    s_cbranch_scc1 FA_PB13
    s_barrier
FA_PB13:
    s_waitcnt vmcnt(3)
    s_add_u32 m0, s52, 104448
    s_mov_b32 s53, 57344
    buffer_load_dwordx4 v109, s[48:51], s53 offen lds
    s_waitcnt vmcnt(3)
    s_add_u32 m0, s52, 108544
    s_mov_b32 s53, 57344
    buffer_load_dwordx4 v110, s[48:51], s53 offen lds
    s_waitcnt vmcnt(3)
    s_mov_b64 exec, s[64:65]
    v_mov_b32 v125, 1
    ds_write_b32 v7, v125 offset:0
    s_mov_b64 exec, -1
    s_add_u32 m0, s52, 114688
    s_mov_b32 s53, 114688
    buffer_load_dwordx4 v108, s[48:51], s53 offen lds
    s_waitcnt vmcnt(3)
    s_add_u32 m0, s52, 118784
    s_mov_b32 s53, 114688
    buffer_load_dwordx4 v109, s[48:51], s53 offen lds
    s_waitcnt vmcnt(3)
    s_add_u32 m0, s52, 122880
    s_mov_b32 s53, 114688
    buffer_load_dwordx4 v110, s[48:51], s53 offen lds
    s_waitcnt vmcnt(3)
    s_mov_b64 exec, s[64:65]
    v_mov_b32 v125, 2
    ds_write_b32 v7, v125 offset:0
    s_mov_b64 exec, -1
    s_add_u32 m0, s52, 129024
    s_mov_b32 s53, 172032
    buffer_load_dwordx4 v108, s[48:51], s53 offen lds
    s_waitcnt vmcnt(3)
    s_add_u32 m0, s52, 133120
    s_mov_b32 s53, 172032
    buffer_load_dwordx4 v109, s[48:51], s53 offen lds
    s_waitcnt vmcnt(3)
    s_add_u32 m0, s52, 137216
    s_mov_b32 s53, 172032
    buffer_load_dwordx4 v110, s[48:51], s53 offen lds
    s_waitcnt vmcnt(3)
    s_mov_b64 exec, s[64:65]
    v_mov_b32 v125, 3
    ds_write_b32 v7, v125 offset:0
    s_mov_b64 exec, -1
    s_add_u32 m0, s52, 143360
    s_mov_b32 s53, 229376
    buffer_load_dwordx4 v108, s[48:51], s53 offen lds
    s_waitcnt vmcnt(3)
    s_add_u32 m0, s52, 147456
    s_mov_b32 s53, 229376
    buffer_load_dwordx4 v109, s[48:51], s53 offen lds
    s_waitcnt vmcnt(3)
    s_add_u32 m0, s52, 151552
    s_mov_b32 s53, 229376
    buffer_load_dwordx4 v110, s[48:51], s53 offen lds
    s_waitcnt vmcnt(3)
    s_mov_b64 exec, s[64:65]
    v_mov_b32 v125, 4
    ds_write_b32 v7, v125 offset:0
    s_mov_b64 exec, -1
    s_mov_b32 s75, 0x40000
FA_SP14:
    ds_read_b32 v124, v7 offset:64
    s_waitcnt lgkmcnt(0)
    v_cmp_le_u32 vcc, 1, v124
    s_sub_u32 s75, s75, 1
    s_cbranch_scc1 FA_SX14
    s_and_b32 s70, vcc_lo, 0xc
    s_cmp_eq_u32 s70, 0xc
    s_cbranch_scc0 FA_SP14
FA_SX14:
    s_add_u32 m0, s52, 57344
    s_mov_b32 s53, 286720
    buffer_load_dwordx4 v108, s[48:51], s53 offen lds
    s_waitcnt vmcnt(3)
    s_add_u32 m0, s52, 61440
    s_mov_b32 s53, 286720
    buffer_load_dwordx4 v109, s[48:51], s53 offen lds
    s_waitcnt vmcnt(3)
    s_add_u32 m0, s52, 65536
    s_mov_b32 s53, 286720
    buffer_load_dwordx4 v110, s[48:51], s53 offen lds
    s_waitcnt vmcnt(3)
    s_mov_b64 exec, s[64:65]
    v_mov_b32 v125, 5
    ds_write_b32 v7, v125 offset:0
    s_mov_b64 exec, -1
    s_add_u32 m0, s52, 71680
    s_mov_b32 s53, 344064
    buffer_load_dwordx4 v108, s[48:51], s53 offen lds
    s_waitcnt vmcnt(3)
    s_add_u32 m0, s52, 75776
    s_mov_b32 s53, 344064
    buffer_load_dwordx4 v109, s[48:51], s53 offen lds
    s_waitcnt vmcnt(3)
    s_add_u32 m0, s52, 79872
    s_mov_b32 s53, 344064
    buffer_load_dwordx4 v110, s[48:51], s53 offen lds
    s_waitcnt vmcnt(3)
    s_mov_b64 exec, s[64:65]
    v_mov_b32 v125, 6
    ds_write_b32 v7, v125 offset:0
    s_mov_b64 exec, -1
    s_waitcnt vmcnt(0)
    s_mov_b64 exec, s[64:65]
    v_mov_b32 v125, 7
    ds_write_b32 v7, v125 offset:0
    s_mov_b64 exec, -1
    s_branch FA_P0
FA_XO:
    s_and_b32 s62, s34, 1
    s_xor_b32 s62, s62, 1
    s_lshl_b32 s60, s62, 5
    s_lshl_b32 s61, s32, 6
    s_add_u32 s61, s61, s60
    v_lshrrev_b32 v8, 3, v0
    v_add_u32 v8, s61, v8
    v_mul_u32_u24 v8, 896, v8
    v_lshrrev_b32 v9, 4, v0
    v_and_b32 v10, 7, v0
    v_xor_b32 v9, v9, v10
    v_lshl_add_u32 v6, v9, 4, v8
    v_xor_b32 v9, 4, v9
    v_lshl_add_u32 v123, v9, 4, v8
    s_lshl_b32 s52, s62, 12
    s_waitcnt lgkmcnt(0)
    s_mov_b32 s48, s4
    s_mov_b32 s49, s5
    s_mov_b32 s50, 0x1c0000
    s_mov_b32 s51, 0x20000
    s_mov_b32 s44, s30
    s_mov_b32 s45, s31
    s_mov_b32 s46, 0x1000000
    s_mov_b32 s47, 0x20000
    s_cmp_lt_u32 s35, 8
    s_cbranch_scc0 FA_PB15
    s_barrier
FA_PB15:
    s_add_u32 m0, s52, 0
    s_mov_b32 s53, 0
    buffer_load_dwordx4 v6, s[48:51], s53 offen lds
    s_add_u32 m0, s52, 1024
    s_mov_b32 s53, 7168
    buffer_load_dwordx4 v123, s[48:51], s53 offen lds
    s_add_u32 m0, s52, 2048
    s_mov_b32 s53, 14336
    buffer_load_dwordx4 v6, s[48:51], s53 offen lds
    s_add_u32 m0, s52, 3072
    s_mov_b32 s53, 21504
    buffer_load_dwordx4 v123, s[48:51], s53 offen lds
    s_lshr_b32 s7, s3, 3
    s_lshl_b32 s60, s7, 1
    s_and_b32 s61, s3, 1
    s_add_u32 s60, s60, s61
    s_bfe_u32 s61, s3, 0x10001
    s_lshl_b32 s62, s61, 2
    s_add_u32 s62, s62, s60
    s_lshl_b32 s62, s62, 11
    s_add_u32 s62, s62, 98304
    v_add_u32 v15, s62, v1
    s_bfe_u32 s58, s3, 0x10002
    s_lshl_b32 s62, s34, 2
    s_add_u32 s60, s60, s62
    s_lshl_b32 s62, s33, 4
    s_add_u32 s60, s60, s62
    s_lshl_b32 s62, s32, 1
    s_add_u32 s61, s61, s62
    s_lshl_b32 s73, s33, 6
    s_add_u32 s73, s73, s61
    s_lshl_b32 s73, s73, 7
    s_add_u32 s73, s73, 0x480000
    s_lshl_b32 s74, s61, 16
    s_lshl_b32 s62, s60, 10
    s_add_u32 s74, s74, s62
    s_add_u32 s74, s74, 0x500000
    s_lshl_b32 s62, s3, 11
    s_lshl_b32 s72, s33, 18
    s_add_u32 s72, s72, s62
    s_add_u32 s72, s72, 0x400000
    s_mov_b32 s59, 0
    s_mov_b32 s8, 0
    v_and_b32 v117, 7, v0
    v_lshlrev_b32 v117, 2, v117
    v_add_u32 v117, 163008, v117
    v_mov_b32 v119, 1
    s_lshl_b32 s6, s33, 2
    s_add_u32 s6, s6, s34
    v_lshrrev_b32 v8, 3, v0
    v_mul_u32_u24 v8, 896, v8
    v_bfe_u32 v9, v0, 1, 2
    v_lshrrev_b32 v10, 4, v0
    v_xor_b32 v9, v9, v10
    v_lshl_add_u32 v8, v9, 5, v8
    v_and_b32 v9, 1, v0
    v_lshl_add_u32 v8, v9, 4, v8
    s_lshl_b32 s62, s6, 7
    v_add_u32 v118, s62, v8
    s_cmp_eq_u32 s7, 0
    s_cselect_b64 s[40:41], s[12:13], s[22:23]
    s_mov_b32 s42, 0x62000
    s_mov_b32 s43, 0x20000
    s_bfe_u32 s62, s3, 0x20001
    s_and_b32 s63, s3, 1
    s_mul_i32 s63, s63, 3
    s_mul_i32 s4, s62, 100352
    s_mul_i32 s5, s63, 7168
    s_add_u32 s4, s4, s5
    s_lshr_b32 s5, s3, 1
    s_mul_i32 s5, s5, 7
    s_add_u32 s5, s5, s63
    s_lshl_b32 s5, s5, 10
    s_add_u32 s5, s5, 98304
    s_and_b32 s11, s3, 3
    s_bfe_u32 s14, s3, 0x10002
    s_and_b32 s62, s34, 1
    s_xor_b32 s14, s14, s62
    s_lshl_b32 s10, s11, 15
    s_lshl_b32 s62, s14, 14
    s_add_u32 s10, s10, s62
    s_cmp_eq_u32 s7, 0
    s_cselect_b32 s10, s10, 0
    s_lshl_b32 s62, s32, 17
    s_add_u32 s10, s10, s62
    s_add_u32 s10, s10, 0x500000
    s_mul_i32 s15, s14, 53248
    s_sub_u32 s15, s15, 98304
    s_mul_i32 s16, s14, 59392
    s_mul_i32 s17, s14, 0xfffe0400
    s_and_b32 s19, s3, 7
    s_lshl_b32 s18, s19, 10
    s_mul_i32 s19, s19, 7168
    s_add_u32 s19, s19, 50176
    s_mov_b32 s36, s26
    s_mov_b32 s37, s27
    s_mov_b32 s38, 0x1c0000
    s_mov_b32 s39, 0x20000
    s_getreg_b32 s20, hwreg(HW_REG_XCC_ID, 0, 16)
    s_lshl_b32 s62, s33, 14
    s_add_u32 s62, s62, 0x900000
    s_and_b32 s63, s2, 7
    s_mul_i32 s63, s63, 0x8000
    s_add_u32 s62, s62, s63
    v_lshl_add_u32 v116, v0, 9, s62
    s_lshl_b32 s62, s58, 14
    v_add_u32 v2, s62, v1
    v_add_u32 v3, 0x10000, v2
    v_mov_b32 v4, 0xdddd
    s_cmp_lt_u32 s35, 8
    s_cbranch_scc1 FA_PB16
    s_barrier
FA_PB16:
    s_waitcnt vmcnt(3)
    s_add_u32 m0, s52, 8192
    s_mov_b32 s53, 128
    buffer_load_dwordx4 v6, s[48:51], s53 offen lds
    s_waitcnt vmcnt(3)
    s_add_u32 m0, s52, 9216
    s_mov_b32 s53, 7296
    buffer_load_dwordx4 v123, s[48:51], s53 offen lds
    s_waitcnt vmcnt(3)
    s_add_u32 m0, s52, 10240
    s_mov_b32 s53, 14464
    buffer_load_dwordx4 v6, s[48:51], s53 offen lds
    s_waitcnt vmcnt(3)
    s_mov_b64 exec, 4
    v_mov_b32 v125, 1
    ds_write_b32 v7, v125 offset:0
    s_mov_b64 exec, -1
    s_add_u32 m0, s52, 11264
    s_mov_b32 s53, 21632
    buffer_load_dwordx4 v123, s[48:51], s53 offen lds
    s_waitcnt vmcnt(3)
    s_add_u32 m0, s52, 16384
    s_mov_b32 s53, 256
    buffer_load_dwordx4 v6, s[48:51], s53 offen lds
    s_waitcnt vmcnt(3)
    s_add_u32 m0, s52, 17408
    s_mov_b32 s53, 7424
    buffer_load_dwordx4 v123, s[48:51], s53 offen lds
    s_waitcnt vmcnt(3)
    s_add_u32 m0, s52, 18432
    s_mov_b32 s53, 14592
    buffer_load_dwordx4 v6, s[48:51], s53 offen lds
    s_waitcnt vmcnt(3)
    s_mov_b64 exec, 4
    v_mov_b32 v125, 2
    ds_write_b32 v7, v125 offset:0
    s_mov_b64 exec, -1
    s_add_u32 m0, s52, 19456
    s_mov_b32 s53, 21760
    buffer_load_dwordx4 v123, s[48:51], s53 offen lds
    s_waitcnt vmcnt(3)
    s_add_u32 m0, s52, 24576
    s_mov_b32 s53, 384
    buffer_load_dwordx4 v6, s[48:51], s53 offen lds
    s_waitcnt vmcnt(3)
    s_add_u32 m0, s52, 25600
    s_mov_b32 s53, 7552
    buffer_load_dwordx4 v123, s[48:51], s53 offen lds
    s_waitcnt vmcnt(3)
    s_add_u32 m0, s52, 26624
    s_mov_b32 s53, 14720
    buffer_load_dwordx4 v6, s[48:51], s53 offen lds
    s_waitcnt vmcnt(3)
    s_mov_b64 exec, 4
    v_mov_b32 v125, 3
    ds_write_b32 v7, v125 offset:0
    s_mov_b64 exec, -1
    s_add_u32 m0, s52, 27648
    s_mov_b32 s53, 21888
    buffer_load_dwordx4 v123, s[48:51], s53 offen lds
    s_waitcnt vmcnt(3)
    s_add_u32 m0, s52, 32768
    s_mov_b32 s53, 512
    buffer_load_dwordx4 v6, s[48:51], s53 offen lds
    s_waitcnt vmcnt(3)
    s_add_u32 m0, s52, 33792
    s_mov_b32 s53, 7680
    buffer_load_dwordx4 v123, s[48:51], s53 offen lds
    s_waitcnt vmcnt(3)
    s_add_u32 m0, s52, 34816
    s_mov_b32 s53, 14848
    buffer_load_dwordx4 v6, s[48:51], s53 offen lds
    s_waitcnt vmcnt(3)
    s_mov_b64 exec, 4
    v_mov_b32 v125, 4
    ds_write_b32 v7, v125 offset:0
    s_mov_b64 exec, -1
    s_add_u32 m0, s52, 35840
    s_mov_b32 s53, 22016
    buffer_load_dwordx4 v123, s[48:51], s53 offen lds
    s_waitcnt vmcnt(3)
    s_add_u32 m0, s52, 40960
    s_mov_b32 s53, 640
    buffer_load_dwordx4 v6, s[48:51], s53 offen lds
    s_waitcnt vmcnt(3)
    s_add_u32 m0, s52, 41984
    s_mov_b32 s53, 7808
    buffer_load_dwordx4 v123, s[48:51], s53 offen lds
    s_waitcnt vmcnt(3)
    s_add_u32 m0, s52, 43008
    s_mov_b32 s53, 14976
    buffer_load_dwordx4 v6, s[48:51], s53 offen lds
    s_waitcnt vmcnt(3)
    s_mov_b64 exec, 4
    v_mov_b32 v125, 5
    ds_write_b32 v7, v125 offset:0
    s_mov_b64 exec, -1
    s_add_u32 m0, s52, 44032
    s_mov_b32 s53, 22144
    buffer_load_dwordx4 v123, s[48:51], s53 offen lds
    s_waitcnt vmcnt(3)
    s_add_u32 m0, s52, 49152
    s_mov_b32 s53, 768
    buffer_load_dwordx4 v6, s[48:51], s53 offen lds
    s_waitcnt vmcnt(3)
    s_add_u32 m0, s52, 50176
    s_mov_b32 s53, 7936
    buffer_load_dwordx4 v123, s[48:51], s53 offen lds
    s_waitcnt vmcnt(3)
    s_add_u32 m0, s52, 51200
    s_mov_b32 s53, 15104
    buffer_load_dwordx4 v6, s[48:51], s53 offen lds
    s_waitcnt vmcnt(3)
    s_mov_b64 exec, 4
    v_mov_b32 v125, 6
    ds_write_b32 v7, v125 offset:0
    s_mov_b64 exec, -1
    s_add_u32 m0, s52, 52224
    s_mov_b32 s53, 22272
    buffer_load_dwordx4 v123, s[48:51], s53 offen lds
    s_waitcnt vmcnt(0)
    s_mov_b64 exec, 4
    v_mov_b32 v125, 7
    ds_write_b32 v7, v125 offset:0
    s_mov_b64 exec, -1
    s_branch FA_P0
FA_HI2:
    s_cmp_lt_u32 s3, 2
    s_cbranch_scc1 FA_KV
    v_mov_b32 v8, 0
    v_cmp_eq_u32 vcc, 1, v0
    s_nop 1
    v_cndmask_b32 v9, 0, 4, vcc
    v_cmp_eq_u32 vcc, 7, v0
    s_nop 1
    v_cndmask_b32 v9, v9, 7, vcc
    v_lshlrev_b32 v10, 2, v0
    v_add_u32 v10, 162816, v10
    ds_write_b32 v10, v9
    s_waitcnt lgkmcnt(0)
    s_mov_b32 s48, s28
    s_mov_b32 s49, s29
    s_mov_b32 s50, 0x100
    s_mov_b32 s51, 0x20000
    s_mov_b32 s44, s30
    s_mov_b32 s45, s31
    s_mov_b32 s46, 0x1000000
    s_mov_b32 s47, 0x20000
    s_cmp_lg_u32 s2, 0
    s_cbranch_scc1 FA_N_POLL
    s_memrealtime s[64:65]
    s_waitcnt lgkmcnt(0)
    s_or_b32 s56, s64, 1
    v_mov_b32 v9, s56
    s_mov_b64 exec, 1
    buffer_store_dword v9, v8, s[48:51], 0 offen sc1
    s_mov_b64 exec, -1
    s_barrier
    s_branch FA_N_GOT
FA_N_POLL:
    buffer_load_dword v9, v8, s[48:51], 0 offen sc1
    s_barrier
    s_mov_b32 s75, 40000
FA_N_LOOP:
    s_waitcnt vmcnt(0)
    v_readfirstlane_b32 s56, v9
    s_sub_u32 s75, s75, 1
    s_cbranch_scc1 FA_N_GOT
    s_cmp_lg_u32 s56, 0
    s_cbranch_scc1 FA_N_GOT
    buffer_load_dword v9, v8, s[48:51], 0 offen sc1
    s_branch FA_N_LOOP
FA_N_GOT:
    s_mov_b64 exec, 1
    v_mov_b32 v125, s56
    ds_write_b32 v7, v125 offset:64
    s_mov_b64 exec, -1
    s_lshr_b32 s7, s3, 3
    s_lshl_b32 s60, s7, 1
    s_and_b32 s61, s3, 1
    s_add_u32 s60, s60, s61
    s_bfe_u32 s61, s3, 0x10001
    s_lshl_b32 s62, s61, 2
    s_add_u32 s62, s62, s60
    s_lshl_b32 s62, s62, 11
    s_add_u32 s62, s62, 98304
    v_add_u32 v15, s62, v1
    s_bfe_u32 s58, s3, 0x10002
    s_lshl_b32 s62, s34, 2
    s_add_u32 s60, s60, s62
    s_lshl_b32 s62, s33, 4
    s_add_u32 s60, s60, s62
    s_lshl_b32 s62, s32, 1
    s_add_u32 s61, s61, s62
    s_lshl_b32 s73, s33, 6
    s_add_u32 s73, s73, s61
    s_lshl_b32 s73, s73, 7
    s_add_u32 s73, s73, 0x480000
    s_lshl_b32 s74, s61, 16
    s_lshl_b32 s62, s60, 10
    s_add_u32 s74, s74, s62
    s_add_u32 s74, s74, 0x500000
    s_lshl_b32 s62, s3, 11
    s_lshl_b32 s72, s33, 18
    s_add_u32 s72, s72, s62
    s_add_u32 s72, s72, 0x400000
    s_mov_b32 s59, 0
    s_mov_b32 s8, 0
    v_and_b32 v117, 7, v0
    v_lshlrev_b32 v117, 2, v117
    v_add_u32 v117, 163008, v117
    v_mov_b32 v119, 1
    s_lshl_b32 s6, s33, 2
    s_add_u32 s6, s6, s34
    v_lshrrev_b32 v8, 3, v0
    v_mul_u32_u24 v8, 896, v8
    v_bfe_u32 v9, v0, 1, 2
    v_lshrrev_b32 v10, 4, v0
    v_xor_b32 v9, v9, v10
    v_lshl_add_u32 v8, v9, 5, v8
    v_and_b32 v9, 1, v0
    v_lshl_add_u32 v8, v9, 4, v8
    s_lshl_b32 s62, s6, 7
    v_add_u32 v118, s62, v8
    s_cmp_eq_u32 s7, 0
    s_cselect_b64 s[40:41], s[12:13], s[22:23]
    s_mov_b32 s42, 0x62000
    s_mov_b32 s43, 0x20000
    s_bfe_u32 s62, s3, 0x20001
    s_and_b32 s63, s3, 1
    s_mul_i32 s63, s63, 3
    s_mul_i32 s4, s62, 100352
    s_mul_i32 s5, s63, 7168
    s_add_u32 s4, s4, s5
    s_lshr_b32 s5, s3, 1
    s_mul_i32 s5, s5, 7
    s_add_u32 s5, s5, s63
    s_lshl_b32 s5, s5, 10
    s_add_u32 s5, s5, 98304
    s_and_b32 s11, s3, 3
    s_bfe_u32 s14, s3, 0x10002
    s_and_b32 s62, s34, 1
    s_xor_b32 s14, s14, s62
    s_lshl_b32 s10, s11, 15
    s_lshl_b32 s62, s14, 14
    s_add_u32 s10, s10, s62
    s_cmp_eq_u32 s7, 0
    s_cselect_b32 s10, s10, 0
    s_lshl_b32 s62, s32, 17
    s_add_u32 s10, s10, s62
    s_add_u32 s10, s10, 0x500000
    s_mul_i32 s15, s14, 53248
    s_sub_u32 s15, s15, 98304
    s_mul_i32 s16, s14, 59392
    s_mul_i32 s17, s14, 0xfffe0400
    s_and_b32 s19, s3, 7
    s_lshl_b32 s18, s19, 10
    s_mul_i32 s19, s19, 7168
    s_add_u32 s19, s19, 50176
    s_mov_b32 s36, s26
    s_mov_b32 s37, s27
    s_mov_b32 s38, 0x1c0000
    s_mov_b32 s39, 0x20000
    s_getreg_b32 s20, hwreg(HW_REG_XCC_ID, 0, 16)
    s_lshl_b32 s62, s33, 14
    s_add_u32 s62, s62, 0x900000
    s_and_b32 s63, s2, 7
    s_mul_i32 s63, s63, 0x8000
    s_add_u32 s62, s62, s63
    v_lshl_add_u32 v116, v0, 9, s62
    s_lshl_b32 s62, s58, 14
    v_add_u32 v2, s62, v1
    v_add_u32 v3, 0x10000, v2
    v_mov_b32 v4, 0xdddd
    s_branch FA_P0
FA_KV:
    s_setprio 3
    v_lshlrev_b32 v4, 1, v0
    s_and_b32 s62, s34, 1
    s_lshl_b32 s60, s62, 5
    s_lshl_b32 s61, s32, 6
    s_add_u32 s61, s61, s60
    v_lshrrev_b32 v8, 3, v0
    v_add_u32 v8, s61, v8
    v_mul_u32_u24 v8, 896, v8
    v_lshrrev_b32 v9, 4, v0
    v_and_b32 v10, 7, v0
    v_xor_b32 v9, v9, v10
    v_lshl_add_u32 v6, v9, 4, v8
    v_xor_b32 v9, 4, v9
    v_lshl_add_u32 v123, v9, 4, v8
    s_lshl_b32 s52, s62, 12
    v_lshrrev_b32 v8, 2, v0
    v_mul_u32_u24 v8, 56, v8
    v_and_b32 v9, 3, v0
    v_lshlrev_b32 v9, 4, v9
    v_min_u32 v9, 40, v9
    v_add_u32 v122, v8, v9
    v_mov_b32 v109, 0
    v_mov_b32 v111, 0
    v_mov_b32 v113, 0
    v_mov_b32 v115, 0
    s_waitcnt lgkmcnt(0)
    s_mov_b32 s48, s24
    s_mov_b32 s49, s25
    s_mov_b32 s50, 0x380
    s_mov_b32 s51, 0x20000
    s_mov_b32 s36, s4
    s_mov_b32 s37, s5
    s_mov_b32 s38, 0x1c0000
    s_mov_b32 s39, 0x20000
    s_cmp_eq_u32 s33, 0
    s_cselect_b64 s[60:61], s[8:9], s[18:19]
    s_cselect_b64 s[62:63], s[10:11], s[20:21]
    s_cmp_lt_u32 s34, 2
    s_cselect_b64 s[40:41], s[60:61], s[62:63]
    s_mov_b32 s42, 0x6200
    s_mov_b32 s43, 0x20000
    s_cmp_eq_u32 s3, 1
    s_cbranch_scc1 FA_KVB_I
    s_cmp_ge_u32 s34, 2
    s_cbranch_scc1 FA_NOGA
    buffer_load_ushort v108, v4, s[48:51], 0 offen
    buffer_load_ushort v110, v4, s[48:51], 0 offen offset:128
    buffer_load_ushort v112, v4, s[48:51], 0 offen offset:256
    buffer_load_ushort v114, v4, s[48:51], 0 offen offset:384
FA_NOGA:
    s_add_u32 m0, s52, 0
    s_mov_b32 s53, 0
    buffer_load_dwordx4 v6, s[36:39], s53 offen lds
    s_mov_b32 m0, 57344
    s_mov_b32 s53, 0
    buffer_load_dwordx4 v122, s[40:43], s53 offen lds
    s_add_u32 m0, s52, 1024
    s_mov_b32 s53, 7168
    buffer_load_dwordx4 v123, s[36:39], s53 offen lds
    s_mov_b32 m0, 58368
    s_mov_b32 s53, 896
    buffer_load_dwordx4 v122, s[40:43], s53 offen lds
    s_add_u32 m0, s52, 2048
    s_mov_b32 s53, 14336
    buffer_load_dwordx4 v6, s[36:39], s53 offen lds
    s_mov_b32 m0, 59392
    s_mov_b32 s53, 1792
    buffer_load_dwordx4 v122, s[40:43], s53 offen lds
    s_add_u32 m0, s52, 3072
    s_mov_b32 s53, 21504
    buffer_load_dwordx4 v123, s[36:39], s53 offen lds
    s_mov_b32 m0, 60416
    s_mov_b32 s53, 2688
    buffer_load_dwordx4 v122, s[40:43], s53 offen lds
    s_add_u32 m0, s52, 8192
    s_mov_b32 s53, 128
    buffer_load_dwordx4 v6, s[36:39], s53 offen lds
    s_mov_b32 m0, 61440
    s_mov_b32 s53, 3584
    buffer_load_dwordx4 v122, s[40:43], s53 offen lds
    s_add_u32 m0, s52, 9216
    s_mov_b32 s53, 7296
    buffer_load_dwordx4 v123, s[36:39], s53 offen lds
    s_mov_b32 m0, 62464
    s_mov_b32 s53, 4480
    buffer_load_dwordx4 v122, s[40:43], s53 offen lds
    s_add_u32 m0, s52, 10240
    s_mov_b32 s53, 14464
    buffer_load_dwordx4 v6, s[36:39], s53 offen lds
    s_mov_b32 m0, 63488
    s_mov_b32 s53, 5376
    buffer_load_dwordx4 v122, s[40:43], s53 offen lds
    s_add_u32 m0, s52, 11264
    s_mov_b32 s53, 21632
    buffer_load_dwordx4 v123, s[36:39], s53 offen lds
    s_mov_b32 m0, 64512
    s_mov_b32 s53, 6272
    buffer_load_dwordx4 v122, s[40:43], s53 offen lds
    s_add_u32 m0, s52, 16384
    s_mov_b32 s53, 256
    buffer_load_dwordx4 v6, s[36:39], s53 offen lds
    s_mov_b32 m0, 65536
    s_mov_b32 s53, 7168
    buffer_load_dwordx4 v122, s[40:43], s53 offen lds
    s_add_u32 m0, s52, 17408
    s_mov_b32 s53, 7424
    buffer_load_dwordx4 v123, s[36:39], s53 offen lds
    s_mov_b32 m0, 66560
    s_mov_b32 s53, 8064
    buffer_load_dwordx4 v122, s[40:43], s53 offen lds
    s_add_u32 m0, s52, 18432
    s_mov_b32 s53, 14592
    buffer_load_dwordx4 v6, s[36:39], s53 offen lds
    s_mov_b32 m0, 67584
    s_mov_b32 s53, 8960
    buffer_load_dwordx4 v122, s[40:43], s53 offen lds
    s_add_u32 m0, s52, 19456
    s_mov_b32 s53, 21760
    buffer_load_dwordx4 v123, s[36:39], s53 offen lds
    s_mov_b32 m0, 68608
    s_mov_b32 s53, 9856
    buffer_load_dwordx4 v122, s[40:43], s53 offen lds
    s_add_u32 m0, s52, 24576
    s_mov_b32 s53, 384
    buffer_load_dwordx4 v6, s[36:39], s53 offen lds
    s_mov_b32 m0, 69632
    s_mov_b32 s53, 10752
    buffer_load_dwordx4 v122, s[40:43], s53 offen lds
    s_add_u32 m0, s52, 25600
    s_mov_b32 s53, 7552
    buffer_load_dwordx4 v123, s[36:39], s53 offen lds
    s_mov_b32 m0, 70656
    s_mov_b32 s53, 11648
    buffer_load_dwordx4 v122, s[40:43], s53 offen lds
    s_add_u32 m0, s52, 26624
    s_mov_b32 s53, 14720
    buffer_load_dwordx4 v6, s[36:39], s53 offen lds
    s_mov_b32 m0, 71680
    s_mov_b32 s53, 12544
    buffer_load_dwordx4 v122, s[40:43], s53 offen lds
    s_add_u32 m0, s52, 27648
    s_mov_b32 s53, 21888
    buffer_load_dwordx4 v123, s[36:39], s53 offen lds
    s_mov_b32 m0, 72704
    s_mov_b32 s53, 13440
    buffer_load_dwordx4 v122, s[40:43], s53 offen lds
    s_branch FA_KV_I
FA_KVB_I:
    s_cmp_ge_u32 s34, 2
    s_cbranch_scc1 FA_NOGB
    buffer_load_ushort v108, v4, s[48:51], 0 offen offset:512
    buffer_load_ushort v110, v4, s[48:51], 0 offen offset:640
    buffer_load_ushort v112, v4, s[48:51], 0 offen offset:768
FA_NOGB:
    s_add_u32 m0, s52, 32768
    s_mov_b32 s53, 512
    buffer_load_dwordx4 v6, s[36:39], s53 offen lds
    s_mov_b32 m0, 73728
    s_mov_b32 s53, 14336
    buffer_load_dwordx4 v122, s[40:43], s53 offen lds
    s_add_u32 m0, s52, 33792
    s_mov_b32 s53, 7680
    buffer_load_dwordx4 v123, s[36:39], s53 offen lds
    s_mov_b32 m0, 74752
    s_mov_b32 s53, 15232
    buffer_load_dwordx4 v122, s[40:43], s53 offen lds
    s_add_u32 m0, s52, 34816
    s_mov_b32 s53, 14848
    buffer_load_dwordx4 v6, s[36:39], s53 offen lds
    s_mov_b32 m0, 75776
    s_mov_b32 s53, 16128
    buffer_load_dwordx4 v122, s[40:43], s53 offen lds
    s_add_u32 m0, s52, 35840
    s_mov_b32 s53, 22016
    buffer_load_dwordx4 v123, s[36:39], s53 offen lds
    s_mov_b32 m0, 76800
    s_mov_b32 s53, 17024
    buffer_load_dwordx4 v122, s[40:43], s53 offen lds
    s_add_u32 m0, s52, 40960
    s_mov_b32 s53, 640
    buffer_load_dwordx4 v6, s[36:39], s53 offen lds
    s_mov_b32 m0, 77824
    s_mov_b32 s53, 17920
    buffer_load_dwordx4 v122, s[40:43], s53 offen lds
    s_add_u32 m0, s52, 41984
    s_mov_b32 s53, 7808
    buffer_load_dwordx4 v123, s[36:39], s53 offen lds
    s_mov_b32 m0, 78848
    s_mov_b32 s53, 18816
    buffer_load_dwordx4 v122, s[40:43], s53 offen lds
    s_add_u32 m0, s52, 43008
    s_mov_b32 s53, 14976
    buffer_load_dwordx4 v6, s[36:39], s53 offen lds
    s_mov_b32 m0, 79872
    s_mov_b32 s53, 19712
    buffer_load_dwordx4 v122, s[40:43], s53 offen lds
    s_add_u32 m0, s52, 44032
    s_mov_b32 s53, 22144
    buffer_load_dwordx4 v123, s[36:39], s53 offen lds
    s_mov_b32 m0, 80896
    s_mov_b32 s53, 20608
    buffer_load_dwordx4 v122, s[40:43], s53 offen lds
    s_add_u32 m0, s52, 49152
    s_mov_b32 s53, 768
    buffer_load_dwordx4 v6, s[36:39], s53 offen lds
    s_mov_b32 m0, 81920
    s_mov_b32 s53, 21504
    buffer_load_dwordx4 v122, s[40:43], s53 offen lds
    s_add_u32 m0, s52, 50176
    s_mov_b32 s53, 7936
    buffer_load_dwordx4 v123, s[36:39], s53 offen lds
    s_mov_b32 m0, 82944
    s_mov_b32 s53, 22400
    buffer_load_dwordx4 v122, s[40:43], s53 offen lds
    s_add_u32 m0, s52, 51200
    s_mov_b32 s53, 15104
    buffer_load_dwordx4 v6, s[36:39], s53 offen lds
    s_mov_b32 m0, 83968
    s_mov_b32 s53, 23296
    buffer_load_dwordx4 v122, s[40:43], s53 offen lds
    s_add_u32 m0, s52, 52224
    s_mov_b32 s53, 22272
    buffer_load_dwordx4 v123, s[36:39], s53 offen lds
    s_mov_b32 m0, 84992
    s_mov_b32 s53, 24192
    buffer_load_dwordx4 v122, s[40:43], s53 offen lds
FA_KV_I:
    s_barrier
    v_bfe_u32 v8, v0, 4, 1
    v_and_b32 v9, 3, v0
    v_lshl_add_u32 v8, v8, 2, v9
    v_lshrrev_b32 v9, 2, v8
    v_lshrrev_b32 v10, 1, v8
    v_and_b32 v9, v9, v10
    v_and_b32 v9, 1, v9
    v_xor_b32 v8, v8, v9
    v_lshlrev_b32 v8, 3, v8
    v_bfe_u32 v9, v0, 2, 2
    v_lshl_add_u32 v8, v9, 6, v8
    v_lshrrev_b32 v9, 5, v0
    v_lshl_add_u32 v8, v9, 9, v8
    v_add_u32 v2, 57344, v8
    v_lshlrev_b32 v8, 6, v0
    v_add_u32 v3, 57392, v8
    v_and_b32 v12, 31, v0
    v_mov_b32 v5, 0x3f803f80
    v_add_u32 v14, 157696, v1
    s_mov_b32 s44, s30
    s_mov_b32 s45, s31
    s_mov_b32 s46, 0x1000000
    s_mov_b32 s47, 0x20000
    s_lshl_b32 s61, s33, 6
    s_lshl_b32 s62, s32, 1
    s_add_u32 s61, s61, s62
    s_and_b32 s62, s34, 1
    s_add_u32 s61, s61, s62
    s_lshl_b32 s73, s61, 7
    s_add_u32 s73, s73, 0x480000
    s_sub_u32 s62, s35, s32
    s_lshl_b32 s62, s62, 1
    s_add_u32 s61, s61, s62
    s_lshl_b32 s74, s61, 12
    s_add_u32 s74, s74, 0x400000
    s_and_b32 s60, s34, 1
    s_lshl_b32 s60, s60, 12
    s_cmp_ge_u32 s34, 2
    s_cbranch_scc1 FA_V
    v_lshrrev_b32 v8, 1, v12
    v_and_b32 v8, 7, v8
    v_lshrrev_b32 v9, 5, v0
    v_xor_b32 v8, v8, v9
    v_lshlrev_b32 v9, 7, v12
    v_lshl_add_u32 v8, v8, 4, v9
    v_add_u32 v104, s60, v8
    v_xor_b32 v105, 32, v104
    v_xor_b32 v106, 64, v104
    v_xor_b32 v107, 96, v104
    s_cmp_eq_u32 s3, 0
    s_cbranch_scc1 FA_KVAk
    s_waitcnt vmcnt(16)
    s_mov_b64 exec, 2
    v_mov_b32 v125, 5
    ds_write_b32 v7, v125 offset:0
    s_mov_b64 exec, -1
    ds_write_b64 v3, v[108:109] offset:16384
    ds_read_b64_tr_b16 v[24:25], v2 offset:16384
    ds_read_b64_tr_b16 v[26:27], v2 offset:16640
    ds_read_b128 v[40:43], v104 offset:32768
    ds_read_b64_tr_b16 v[28:29], v2 offset:17408
    ds_read_b64_tr_b16 v[30:31], v2 offset:17664
    ds_read_b128 v[44:47], v105 offset:32768
    ds_read_b64_tr_b16 v[32:33], v2 offset:18432
    ds_read_b64_tr_b16 v[34:35], v2 offset:18688
    ds_read_b128 v[48:51], v106 offset:32768
    ds_read_b64_tr_b16 v[36:37], v2 offset:19456
    ds_read_b64_tr_b16 v[38:39], v2 offset:19712
    ds_read_b128 v[52:55], v107 offset:32768
    s_waitcnt vmcnt(8)
    s_mov_b64 exec, 2
    v_mov_b32 v125, 6
    ds_write_b32 v7, v125 offset:0
    s_mov_b64 exec, -1
    ds_write_b64 v3, v[110:111] offset:20480
    ds_read_b64_tr_b16 v[56:57], v2 offset:20480
    ds_read_b64_tr_b16 v[58:59], v2 offset:20736
    ds_read_b128 v[72:75], v104 offset:40960
    ds_read_b64_tr_b16 v[60:61], v2 offset:21504
    ds_read_b64_tr_b16 v[62:63], v2 offset:21760
    ds_read_b128 v[76:79], v105 offset:40960
    ds_read_b64_tr_b16 v[64:65], v2 offset:22528
    ds_read_b64_tr_b16 v[66:67], v2 offset:22784
    ds_read_b128 v[80:83], v106 offset:40960
    ds_read_b64_tr_b16 v[68:69], v2 offset:23552
    ds_read_b64_tr_b16 v[70:71], v2 offset:23808
    ds_read_b128 v[84:87], v107 offset:40960
    s_waitcnt lgkmcnt(14)
    v_mfma_f32_32x32x16_bf16 v[88:103], v[24:27], v[40:43], 0
    v_mfma_f32_32x32x16_bf16 v[88:103], v[28:31], v[44:47], v[88:103]
    v_mfma_f32_32x32x16_bf16 v[88:103], v[32:35], v[48:51], v[88:103]
    v_mfma_f32_32x32x16_bf16 v[88:103], v[36:39], v[52:55], v[88:103]
    s_waitcnt vmcnt(0)
    s_mov_b64 exec, 2
    v_mov_b32 v125, 7
    ds_write_b32 v7, v125 offset:0
    s_mov_b64 exec, -1
    ds_write_b64 v3, v[112:113] offset:24576
    ds_read_b64_tr_b16 v[24:25], v2 offset:24576
    ds_read_b64_tr_b16 v[26:27], v2 offset:24832
    ds_read_b128 v[40:43], v104 offset:49152
    ds_read_b64_tr_b16 v[28:29], v2 offset:25600
    ds_read_b64_tr_b16 v[30:31], v2 offset:25856
    ds_read_b128 v[44:47], v105 offset:49152
    ds_read_b64_tr_b16 v[32:33], v2 offset:26624
    ds_read_b64_tr_b16 v[34:35], v2 offset:26880
    ds_read_b128 v[48:51], v106 offset:49152
    ds_read_b64_tr_b16 v[36:37], v2 offset:27648
    ds_read_b64_tr_b16 v[38:39], v2 offset:27904
    ds_read_b128 v[52:55], v107 offset:49152
    s_waitcnt lgkmcnt(14)
    v_mfma_f32_32x32x16_bf16 v[88:103], v[56:59], v[72:75], v[88:103]
    v_mfma_f32_32x32x16_bf16 v[88:103], v[60:63], v[76:79], v[88:103]
    v_mfma_f32_32x32x16_bf16 v[88:103], v[64:67], v[80:83], v[88:103]
    v_mfma_f32_32x32x16_bf16 v[88:103], v[68:71], v[84:87], v[88:103]
    s_waitcnt lgkmcnt(0)
    s_mov_b64 exec, 8
    v_mov_b32 v125, 1
    ds_write_b32 v7, v125 offset:64
    s_mov_b64 exec, -1
    v_mfma_f32_32x32x16_bf16 v[88:103], v[24:27], v[40:43], v[88:103]
    v_mfma_f32_32x32x16_bf16 v[88:103], v[28:31], v[44:47], v[88:103]
    v_mfma_f32_32x32x16_bf16 v[88:103], v[32:35], v[48:51], v[88:103]
    v_mfma_f32_32x32x16_bf16 v[88:103], v[36:39], v[52:55], v[88:103]
    s_nop 7
    s_nop 3
    ds_write_b128 v14, v[88:91] offset:0
    ds_write_b128 v14, v[92:95] offset:1024
    ds_write_b128 v14, v[96:99] offset:2048
    ds_write_b128 v14, v[100:103] offset:3072
    s_mov_b64 exec, 16
    v_mov_b32 v125, 1
    ds_write_b32 v7, v125 offset:64
    s_mov_b64 exec, -1
    s_branch FA_KVB_DONE
FA_KVAk:
    s_waitcnt vmcnt(24)
    s_mov_b64 exec, 1
    v_mov_b32 v125, 1
    ds_write_b32 v7, v125 offset:0
    s_mov_b64 exec, -1
    ds_write_b64 v3, v[108:109] offset:0
    ds_read_b64_tr_b16 v[24:25], v2 offset:0
    ds_read_b64_tr_b16 v[26:27], v2 offset:256
    ds_read_b128 v[40:43], v104 offset:0
    ds_read_b64_tr_b16 v[28:29], v2 offset:1024
    ds_read_b64_tr_b16 v[30:31], v2 offset:1280
    ds_read_b128 v[44:47], v105 offset:0
    ds_read_b64_tr_b16 v[32:33], v2 offset:2048
    ds_read_b64_tr_b16 v[34:35], v2 offset:2304
    ds_read_b128 v[48:51], v106 offset:0
    ds_read_b64_tr_b16 v[36:37], v2 offset:3072
    ds_read_b64_tr_b16 v[38:39], v2 offset:3328
    ds_read_b128 v[52:55], v107 offset:0
    s_waitcnt vmcnt(16)
    s_mov_b64 exec, 1
    v_mov_b32 v125, 2
    ds_write_b32 v7, v125 offset:0
    s_mov_b64 exec, -1
    ds_write_b64 v3, v[110:111] offset:4096
    ds_read_b64_tr_b16 v[56:57], v2 offset:4096
    ds_read_b64_tr_b16 v[58:59], v2 offset:4352
    ds_read_b128 v[72:75], v104 offset:8192
    ds_read_b64_tr_b16 v[60:61], v2 offset:5120
    ds_read_b64_tr_b16 v[62:63], v2 offset:5376
    ds_read_b128 v[76:79], v105 offset:8192
    ds_read_b64_tr_b16 v[64:65], v2 offset:6144
    ds_read_b64_tr_b16 v[66:67], v2 offset:6400
    ds_read_b128 v[80:83], v106 offset:8192
    ds_read_b64_tr_b16 v[68:69], v2 offset:7168
    ds_read_b64_tr_b16 v[70:71], v2 offset:7424
    ds_read_b128 v[84:87], v107 offset:8192
    s_waitcnt lgkmcnt(14)
    v_mfma_f32_32x32x16_bf16 v[88:103], v[24:27], v[40:43], 0
    v_mfma_f32_32x32x16_bf16 v[88:103], v[28:31], v[44:47], v[88:103]
    v_mfma_f32_32x32x16_bf16 v[88:103], v[32:35], v[48:51], v[88:103]
    v_mfma_f32_32x32x16_bf16 v[88:103], v[36:39], v[52:55], v[88:103]
    s_waitcnt vmcnt(8)
    s_mov_b64 exec, 1
    v_mov_b32 v125, 3
    ds_write_b32 v7, v125 offset:0
    s_mov_b64 exec, -1
    ds_write_b64 v3, v[112:113] offset:8192
    ds_read_b64_tr_b16 v[24:25], v2 offset:8192
    ds_read_b64_tr_b16 v[26:27], v2 offset:8448
    ds_read_b128 v[40:43], v104 offset:16384
    ds_read_b64_tr_b16 v[28:29], v2 offset:9216
    ds_read_b64_tr_b16 v[30:31], v2 offset:9472
    ds_read_b128 v[44:47], v105 offset:16384
    ds_read_b64_tr_b16 v[32:33], v2 offset:10240
    ds_read_b64_tr_b16 v[34:35], v2 offset:10496
    ds_read_b128 v[48:51], v106 offset:16384
    ds_read_b64_tr_b16 v[36:37], v2 offset:11264
    ds_read_b64_tr_b16 v[38:39], v2 offset:11520
    ds_read_b128 v[52:55], v107 offset:16384
    s_waitcnt lgkmcnt(14)
    v_mfma_f32_32x32x16_bf16 v[88:103], v[56:59], v[72:75], v[88:103]
    v_mfma_f32_32x32x16_bf16 v[88:103], v[60:63], v[76:79], v[88:103]
    v_mfma_f32_32x32x16_bf16 v[88:103], v[64:67], v[80:83], v[88:103]
    v_mfma_f32_32x32x16_bf16 v[88:103], v[68:71], v[84:87], v[88:103]
    s_waitcnt vmcnt(0)
    s_mov_b64 exec, 1
    v_mov_b32 v125, 7
    ds_write_b32 v7, v125 offset:0
    s_mov_b64 exec, -1
    ds_write_b64 v3, v[114:115] offset:12288
    ds_read_b64_tr_b16 v[56:57], v2 offset:12288
    ds_read_b64_tr_b16 v[58:59], v2 offset:12544
    ds_read_b128 v[72:75], v104 offset:24576
    ds_read_b64_tr_b16 v[60:61], v2 offset:13312
    ds_read_b64_tr_b16 v[62:63], v2 offset:13568
    ds_read_b128 v[76:79], v105 offset:24576
    ds_read_b64_tr_b16 v[64:65], v2 offset:14336
    ds_read_b64_tr_b16 v[66:67], v2 offset:14592
    ds_read_b128 v[80:83], v106 offset:24576
    ds_read_b64_tr_b16 v[68:69], v2 offset:15360
    ds_read_b64_tr_b16 v[70:71], v2 offset:15616
    ds_read_b128 v[84:87], v107 offset:24576
    s_waitcnt lgkmcnt(14)
    v_mfma_f32_32x32x16_bf16 v[88:103], v[24:27], v[40:43], v[88:103]
    v_mfma_f32_32x32x16_bf16 v[88:103], v[28:31], v[44:47], v[88:103]
    v_mfma_f32_32x32x16_bf16 v[88:103], v[32:35], v[48:51], v[88:103]
    v_mfma_f32_32x32x16_bf16 v[88:103], v[36:39], v[52:55], v[88:103]
    s_waitcnt lgkmcnt(0)
    s_mov_b64 exec, 4
    v_mov_b32 v125, 1
    ds_write_b32 v7, v125 offset:64
    s_mov_b64 exec, -1
    v_mfma_f32_32x32x16_bf16 v[88:103], v[56:59], v[72:75], v[88:103]
    v_mfma_f32_32x32x16_bf16 v[88:103], v[60:63], v[76:79], v[88:103]
    v_mfma_f32_32x32x16_bf16 v[88:103], v[64:67], v[80:83], v[88:103]
    v_mfma_f32_32x32x16_bf16 v[88:103], v[68:71], v[84:87], v[88:103]
    s_nop 0
    s_mov_b32 s75, 0x40000
FA_SP17:
    ds_read_b32 v124, v7 offset:64
    s_waitcnt lgkmcnt(0)
    v_cmp_le_u32 vcc, 1, v124
    s_sub_u32 s75, s75, 1
    s_cbranch_scc1 FA_SX17
    s_and_b32 s70, vcc_lo, 0x10
    s_cmp_eq_u32 s70, 0x10
    s_cbranch_scc0 FA_SP17
FA_SX17:
    ds_read_b128 v[24:27], v14 offset:0
    ds_read_b128 v[28:31], v14 offset:1024
    ds_read_b128 v[32:35], v14 offset:2048
    ds_read_b128 v[36:39], v14 offset:3072
    s_waitcnt lgkmcnt(0)
    v_pk_add_f32 v[88:89], v[88:89], v[24:25]
    v_pk_add_f32 v[90:91], v[90:91], v[26:27]
    v_pk_add_f32 v[92:93], v[92:93], v[28:29]
    v_pk_add_f32 v[94:95], v[94:95], v[30:31]
    v_pk_add_f32 v[96:97], v[96:97], v[32:33]
    v_pk_add_f32 v[98:99], v[98:99], v[34:35]
    v_pk_add_f32 v[100:101], v[100:101], v[36:37]
    v_pk_add_f32 v[102:103], v[102:103], v[38:39]
    s_mov_b32 s60, 0x3fb8aa3b
    s_xor_b32 s62, s60, 0x80000000
    s_cmp_eq_u32 s33, 0
    s_cselect_b32 s60, s62, s60
    v_and_b32 v9, 31, v0
    v_lshlrev_b32 v9, 2, v9
    v_cvt_pk_bf16_f32 v24, v88, v89
    v_cvt_pk_bf16_f32 v25, v90, v91
    v_cvt_pk_bf16_f32 v26, v92, v93
    v_cvt_pk_bf16_f32 v27, v94, v95
    v_cvt_pk_bf16_f32 v28, v96, v97
    v_cvt_pk_bf16_f32 v29, v98, v99
    v_cvt_pk_bf16_f32 v30, v100, v101
    v_cvt_pk_bf16_f32 v31, v102, v103
    s_mov_b32 exec_lo, 0
    v_mul_f32 v10, s60, v100
    v_mov_b32 v30, 0x3f803f80
    v_exp_f32 v10, v10
    v_mov_b32 v31, 0x3f80
    v_add_f32 v10, 1.0, v10
    v_rcp_f32 v10, v10
    s_mov_b32 exec_lo, -1
    buffer_store_dwordx4 v[24:27], v1, s[44:47], s74 offen sc1
    buffer_store_dwordx4 v[28:31], v1, s[44:47], s74 offen offset:1024 sc1
    s_mov_b32 exec_lo, 0
    buffer_store_dword v10, v9, s[44:47], s73 offen sc1
    s_mov_b32 exec_lo, -1
    s_branch FA_KV_DONE
FA_V:
    v_and_b32 v8, 0x13, v12
    v_bfe_u32 v9, v12, 2, 1
    v_lshl_or_b32 v8, v9, 3, v8
    v_bfe_u32 v9, v12, 3, 1
    v_lshl_or_b32 v12, v9, 2, v8
    v_lshrrev_b32 v8, 1, v12
    v_and_b32 v8, 7, v8
    v_lshrrev_b32 v9, 5, v0
    v_xor_b32 v8, v8, v9
    v_lshlrev_b32 v9, 7, v12
    v_lshl_add_u32 v8, v8, 4, v9
    v_add_u32 v104, s60, v8
    v_xor_b32 v105, 32, v104
    v_xor_b32 v106, 64, v104
    v_xor_b32 v107, 96, v104
    v_and_b32 v8, 31, v0
    v_subrev_u32 v9, 16, v8
    v_mul_u32_u24 v10, 43, v9
    v_lshrrev_b32 v10, 7, v10
    v_mul_u32_u24 v11, 3, v10
    v_sub_u32 v11, v9, v11
    v_cmp_le_u32 vcc, 28, v8
    s_nop 0
    v_subrev_u32 v9, 28, v8
    v_cndmask_b32 v10, v10, v9, vcc
    v_cndmask_b32 v11, v11, 3, vcc
    v_add_u32 v11, 8, v11
    v_cmp_gt_u32 vcc, 16, v8
    v_lshrrev_b32 v9, 2, v8
    v_and_b32 v8, 3, v8
    v_cndmask_b32 v10, v10, v9, vcc
    v_cndmask_b32 v11, v11, v8, vcc
    v_and_b32 v8, 1, v10
    v_lshl_add_u32 v11, v8, 2, v11
    v_lshrrev_b32 v10, 1, v10
    v_lshl_add_u32 v11, v10, 4, v11
    v_and_or_b32 v11, v0, 32, v11
    v_lshlrev_b32 v121, 4, v11
    s_cmp_eq_u32 s3, 0
    s_cbranch_scc1 FA_KVAv
    s_waitcnt vmcnt(16)
    s_mov_b64 exec, 2
    v_mov_b32 v125, 5
    ds_write_b32 v7, v125 offset:0
    s_mov_b64 exec, -1
    ds_read_b64_tr_b16 v[24:25], v2 offset:16384
    ds_read_b64_tr_b16 v[26:27], v2 offset:16640
    ds_read_b128 v[40:43], v104 offset:32768
    ds_read_b64_tr_b16 v[28:29], v2 offset:17408
    ds_read_b64_tr_b16 v[30:31], v2 offset:17664
    ds_read_b128 v[44:47], v105 offset:32768
    ds_read_b64_tr_b16 v[32:33], v2 offset:18432
    ds_read_b64_tr_b16 v[34:35], v2 offset:18688
    ds_read_b128 v[48:51], v106 offset:32768
    ds_read_b64_tr_b16 v[36:37], v2 offset:19456
    ds_read_b64_tr_b16 v[38:39], v2 offset:19712
    ds_read_b128 v[52:55], v107 offset:32768
    s_waitcnt vmcnt(8)
    s_mov_b64 exec, 2
    v_mov_b32 v125, 6
    ds_write_b32 v7, v125 offset:0
    s_mov_b64 exec, -1
    ds_read_b64_tr_b16 v[56:57], v2 offset:20480
    ds_read_b64_tr_b16 v[58:59], v2 offset:20736
    ds_read_b128 v[72:75], v104 offset:40960
    ds_read_b64_tr_b16 v[60:61], v2 offset:21504
    ds_read_b64_tr_b16 v[62:63], v2 offset:21760
    ds_read_b128 v[76:79], v105 offset:40960
    ds_read_b64_tr_b16 v[64:65], v2 offset:22528
    ds_read_b64_tr_b16 v[66:67], v2 offset:22784
    ds_read_b128 v[80:83], v106 offset:40960
    ds_read_b64_tr_b16 v[68:69], v2 offset:23552
    ds_read_b64_tr_b16 v[70:71], v2 offset:23808
    ds_read_b128 v[84:87], v107 offset:40960
    s_waitcnt lgkmcnt(13)
    v_mfma_f32_32x32x16_bf16 v[88:103], v[40:43], v[24:27], 0
    v_mfma_f32_32x32x16_bf16 v[88:103], v[44:47], v[28:31], v[88:103]
    v_mfma_f32_32x32x16_bf16 v[88:103], v[48:51], v[32:35], v[88:103]
    v_mfma_f32_32x32x16_bf16 v[88:103], v[52:55], v[36:39], v[88:103]
    s_waitcnt vmcnt(0)
    s_mov_b64 exec, 2
    v_mov_b32 v125, 7
    ds_write_b32 v7, v125 offset:0
    s_mov_b64 exec, -1
    ds_read_b64_tr_b16 v[24:25], v2 offset:24576
    ds_read_b64_tr_b16 v[26:27], v2 offset:24832
    ds_read_b128 v[40:43], v104 offset:49152
    ds_read_b64_tr_b16 v[28:29], v2 offset:25600
    ds_read_b64_tr_b16 v[30:31], v2 offset:25856
    ds_read_b128 v[44:47], v105 offset:49152
    ds_read_b64_tr_b16 v[32:33], v2 offset:26624
    ds_read_b64_tr_b16 v[34:35], v2 offset:26880
    ds_read_b128 v[48:51], v106 offset:49152
    ds_read_b64_tr_b16 v[36:37], v2 offset:27648
    ds_read_b64_tr_b16 v[38:39], v2 offset:27904
    ds_read_b128 v[52:55], v107 offset:49152
    s_waitcnt lgkmcnt(13)
    v_mfma_f32_32x32x16_bf16 v[88:103], v[72:75], v[56:59], v[88:103]
    v_mfma_f32_32x32x16_bf16 v[88:103], v[76:79], v[60:63], v[88:103]
    v_mfma_f32_32x32x16_bf16 v[88:103], v[80:83], v[64:67], v[88:103]
    v_mfma_f32_32x32x16_bf16 v[88:103], v[84:87], v[68:71], v[88:103]
    s_waitcnt lgkmcnt(0)
    s_mov_b64 exec, 8
    v_mov_b32 v125, 1
    ds_write_b32 v7, v125 offset:64
    s_mov_b64 exec, -1
    v_mfma_f32_32x32x16_bf16 v[88:103], v[40:43], v[24:27], v[88:103]
    v_mfma_f32_32x32x16_bf16 v[88:103], v[44:47], v[28:31], v[88:103]
    v_mfma_f32_32x32x16_bf16 v[88:103], v[48:51], v[32:35], v[88:103]
    v_mfma_f32_32x32x16_bf16 v[88:103], v[52:55], v[36:39], v[88:103]
    s_nop 7
    s_nop 3
    ds_write_b128 v14, v[88:91] offset:0
    ds_write_b128 v14, v[92:95] offset:1024
    ds_write_b128 v14, v[96:99] offset:2048
    ds_write_b128 v14, v[100:103] offset:3072
    s_mov_b64 exec, 16
    v_mov_b32 v125, 1
    ds_write_b32 v7, v125 offset:64
    s_mov_b64 exec, -1
    s_branch FA_KVB_DONE
FA_KVAv:
    s_waitcnt vmcnt(24)
    s_mov_b64 exec, 1
    v_mov_b32 v125, 1
    ds_write_b32 v7, v125 offset:0
    s_mov_b64 exec, -1
    ds_read_b64_tr_b16 v[24:25], v2 offset:0
    ds_read_b64_tr_b16 v[26:27], v2 offset:256
    ds_read_b128 v[40:43], v104 offset:0
    ds_read_b64_tr_b16 v[28:29], v2 offset:1024
    ds_read_b64_tr_b16 v[30:31], v2 offset:1280
    ds_read_b128 v[44:47], v105 offset:0
    ds_read_b64_tr_b16 v[32:33], v2 offset:2048
    ds_read_b64_tr_b16 v[34:35], v2 offset:2304
    ds_read_b128 v[48:51], v106 offset:0
    ds_read_b64_tr_b16 v[36:37], v2 offset:3072
    ds_read_b64_tr_b16 v[38:39], v2 offset:3328
    ds_read_b128 v[52:55], v107 offset:0
    s_waitcnt vmcnt(16)
    s_mov_b64 exec, 1
    v_mov_b32 v125, 2
    ds_write_b32 v7, v125 offset:0
    s_mov_b64 exec, -1
    ds_read_b64_tr_b16 v[56:57], v2 offset:4096
    ds_read_b64_tr_b16 v[58:59], v2 offset:4352
    ds_read_b128 v[72:75], v104 offset:8192
    ds_read_b64_tr_b16 v[60:61], v2 offset:5120
    ds_read_b64_tr_b16 v[62:63], v2 offset:5376
    ds_read_b128 v[76:79], v105 offset:8192
    ds_read_b64_tr_b16 v[64:65], v2 offset:6144
    ds_read_b64_tr_b16 v[66:67], v2 offset:6400
    ds_read_b128 v[80:83], v106 offset:8192
    ds_read_b64_tr_b16 v[68:69], v2 offset:7168
    ds_read_b64_tr_b16 v[70:71], v2 offset:7424
    ds_read_b128 v[84:87], v107 offset:8192
    s_waitcnt lgkmcnt(13)
    v_mfma_f32_32x32x16_bf16 v[88:103], v[40:43], v[24:27], 0
    v_mfma_f32_32x32x16_bf16 v[88:103], v[44:47], v[28:31], v[88:103]
    v_mfma_f32_32x32x16_bf16 v[88:103], v[48:51], v[32:35], v[88:103]
    v_mfma_f32_32x32x16_bf16 v[88:103], v[52:55], v[36:39], v[88:103]
    s_waitcnt vmcnt(8)
    s_mov_b64 exec, 1
    v_mov_b32 v125, 3
    ds_write_b32 v7, v125 offset:0
    s_mov_b64 exec, -1
    ds_read_b64_tr_b16 v[24:25], v2 offset:8192
    ds_read_b64_tr_b16 v[26:27], v2 offset:8448
    ds_read_b128 v[40:43], v104 offset:16384
    ds_read_b64_tr_b16 v[28:29], v2 offset:9216
    ds_read_b64_tr_b16 v[30:31], v2 offset:9472
    ds_read_b128 v[44:47], v105 offset:16384
    ds_read_b64_tr_b16 v[32:33], v2 offset:10240
    ds_read_b64_tr_b16 v[34:35], v2 offset:10496
    ds_read_b128 v[48:51], v106 offset:16384
    ds_read_b64_tr_b16 v[36:37], v2 offset:11264
    ds_read_b64_tr_b16 v[38:39], v2 offset:11520
    ds_read_b128 v[52:55], v107 offset:16384
    s_waitcnt lgkmcnt(13)
    v_mfma_f32_32x32x16_bf16 v[88:103], v[72:75], v[56:59], v[88:103]
    v_mfma_f32_32x32x16_bf16 v[88:103], v[76:79], v[60:63], v[88:103]
    v_mfma_f32_32x32x16_bf16 v[88:103], v[80:83], v[64:67], v[88:103]
    v_mfma_f32_32x32x16_bf16 v[88:103], v[84:87], v[68:71], v[88:103]
    s_waitcnt vmcnt(0)
    s_mov_b64 exec, 1
    v_mov_b32 v125, 7
    ds_write_b32 v7, v125 offset:0
    s_mov_b64 exec, -1
    ds_read_b64_tr_b16 v[56:57], v2 offset:12288
    ds_read_b64_tr_b16 v[58:59], v2 offset:12544
    ds_read_b128 v[72:75], v104 offset:24576
    ds_read_b64_tr_b16 v[60:61], v2 offset:13312
    ds_read_b64_tr_b16 v[62:63], v2 offset:13568
    ds_read_b128 v[76:79], v105 offset:24576
    ds_read_b64_tr_b16 v[64:65], v2 offset:14336
    ds_read_b64_tr_b16 v[66:67], v2 offset:14592
    ds_read_b128 v[80:83], v106 offset:24576
    ds_read_b64_tr_b16 v[68:69], v2 offset:15360
    ds_read_b64_tr_b16 v[70:71], v2 offset:15616
    ds_read_b128 v[84:87], v107 offset:24576
    s_waitcnt lgkmcnt(13)
    v_mfma_f32_32x32x16_bf16 v[88:103], v[40:43], v[24:27], v[88:103]
    v_mfma_f32_32x32x16_bf16 v[88:103], v[44:47], v[28:31], v[88:103]
    v_mfma_f32_32x32x16_bf16 v[88:103], v[48:51], v[32:35], v[88:103]
    v_mfma_f32_32x32x16_bf16 v[88:103], v[52:55], v[36:39], v[88:103]
    s_waitcnt lgkmcnt(0)
    s_mov_b64 exec, 4
    v_mov_b32 v125, 1
    ds_write_b32 v7, v125 offset:64
    s_mov_b64 exec, -1
    v_mfma_f32_32x32x16_bf16 v[88:103], v[72:75], v[56:59], v[88:103]
    v_mfma_f32_32x32x16_bf16 v[88:103], v[76:79], v[60:63], v[88:103]
    v_mfma_f32_32x32x16_bf16 v[88:103], v[80:83], v[64:67], v[88:103]
    v_mfma_f32_32x32x16_bf16 v[88:103], v[84:87], v[68:71], v[88:103]
    s_nop 0
    s_mov_b32 s75, 0x40000
FA_SP18:
    ds_read_b32 v124, v7 offset:64
    s_waitcnt lgkmcnt(0)
    v_cmp_le_u32 vcc, 1, v124
    s_sub_u32 s75, s75, 1
    s_cbranch_scc1 FA_SX18
    s_and_b32 s70, vcc_lo, 0x10
    s_cmp_eq_u32 s70, 0x10
    s_cbranch_scc0 FA_SP18
FA_SX18:
    ds_read_b128 v[24:27], v14 offset:0
    ds_read_b128 v[28:31], v14 offset:1024
    ds_read_b128 v[32:35], v14 offset:2048
    ds_read_b128 v[36:39], v14 offset:3072
    s_waitcnt lgkmcnt(0)
    v_pk_add_f32 v[88:89], v[88:89], v[24:25]
    v_pk_add_f32 v[90:91], v[90:91], v[26:27]
    v_pk_add_f32 v[92:93], v[92:93], v[28:29]
    v_pk_add_f32 v[94:95], v[94:95], v[30:31]
    v_pk_add_f32 v[96:97], v[96:97], v[32:33]
    v_pk_add_f32 v[98:99], v[98:99], v[34:35]
    v_pk_add_f32 v[100:101], v[100:101], v[36:37]
    v_pk_add_f32 v[102:103], v[102:103], v[38:39]
    s_add_u32 s74, s74, 2048
    v_cvt_pk_bf16_f32 v24, v88, v89
    v_cvt_pk_bf16_f32 v25, v90, v91
    v_cvt_pk_bf16_f32 v26, v92, v93
    v_cvt_pk_bf16_f32 v27, v94, v95
    v_cvt_pk_bf16_f32 v28, v96, v97
    v_cvt_pk_bf16_f32 v29, v98, v99
    v_cvt_pk_bf16_f32 v30, v100, v101
    v_cvt_pk_bf16_f32 v31, v102, v103
    s_mov_b32 exec_lo, 0xf0000000
    s_mov_b32 exec_hi, 0xf0000000
    v_mov_b32 v24, v5
    v_mov_b32 v25, v5
    v_mov_b32 v26, v5
    v_mov_b32 v27, v5
    v_mov_b32 v28, v5
    v_mov_b32 v29, v5
    v_mov_b32 v30, v5
    v_mov_b32 v31, v5
    s_mov_b64 exec, -1
    buffer_store_dwordx4 v[24:27], v121, s[44:47], s74 offen sc1
    buffer_store_dwordx4 v[28:31], v121, s[44:47], s74 offen offset:1024 sc1
FA_KV_DONE:
    s_mov_b32 s75, 0x40000
FA_SP19:
    ds_read_b32 v124, v7 offset:64
    s_waitcnt lgkmcnt(0)
    v_cmp_le_u32 vcc, 1, v124
    s_sub_u32 s75, s75, 1
    s_cbranch_scc1 FA_SX19
    s_and_b32 s70, vcc_lo, 0x1
    s_cmp_eq_u32 s70, 0x1
    s_cbranch_scc0 FA_SP19
FA_SX19:
    v_readfirstlane_b32 s56, v124
    s_lshl_b32 s60, s33, 5
    s_add_u32 s60, s60, s35
    s_lshl_b32 s60, s60, 9
    s_lshl_b32 s61, s34, 7
    s_add_u32 s60, s60, s61
    s_add_u32 s60, s60, 0x900000
    s_getreg_b32 s61, hwreg(HW_REG_XCC_ID, 0, 16)
    v_mul_u32_u24 v8, 0x8000, v0
    v_mov_b32 v10, s56
    v_mov_b32 v11, s61
    s_waitcnt vmcnt(0)
    s_mov_b64 exec, 0xff
    buffer_store_dwordx2 v[10:11], v8, s[44:47], s60 offen sc1
    s_mov_b64 exec, -1
    s_mov_b64 exec, 32
    v_mov_b32 v125, 1
    ds_write_b32 v7, v125 offset:64
    s_mov_b64 exec, -1
    s_setprio 0
    s_lshr_b32 s7, s3, 3
    s_lshl_b32 s60, s7, 1
    s_and_b32 s61, s3, 1
    s_add_u32 s60, s60, s61
    s_bfe_u32 s61, s3, 0x10001
    s_lshl_b32 s62, s61, 2
    s_add_u32 s62, s62, s60
    s_lshl_b32 s62, s62, 11
    s_add_u32 s62, s62, 98304
    v_add_u32 v15, s62, v1
    s_bfe_u32 s58, s3, 0x10002
    s_lshl_b32 s62, s34, 2
    s_add_u32 s60, s60, s62
    s_lshl_b32 s62, s33, 4
    s_add_u32 s60, s60, s62
    s_lshl_b32 s62, s32, 1
    s_add_u32 s61, s61, s62
    s_lshl_b32 s73, s33, 6
    s_add_u32 s73, s73, s61
    s_lshl_b32 s73, s73, 7
    s_add_u32 s73, s73, 0x480000
    s_lshl_b32 s74, s61, 16
    s_lshl_b32 s62, s60, 10
    s_add_u32 s74, s74, s62
    s_add_u32 s74, s74, 0x500000
    s_lshl_b32 s62, s3, 11
    s_lshl_b32 s72, s33, 18
    s_add_u32 s72, s72, s62
    s_add_u32 s72, s72, 0x400000
    s_mov_b32 s59, 0
    s_mov_b32 s8, 0
    v_and_b32 v117, 7, v0
    v_lshlrev_b32 v117, 2, v117
    v_add_u32 v117, 163008, v117
    v_mov_b32 v119, 1
    s_lshl_b32 s6, s33, 2
    s_add_u32 s6, s6, s34
    v_lshrrev_b32 v8, 3, v0
    v_mul_u32_u24 v8, 896, v8
    v_bfe_u32 v9, v0, 1, 2
    v_lshrrev_b32 v10, 4, v0
    v_xor_b32 v9, v9, v10
    v_lshl_add_u32 v8, v9, 5, v8
    v_and_b32 v9, 1, v0
    v_lshl_add_u32 v8, v9, 4, v8
    s_lshl_b32 s62, s6, 7
    v_add_u32 v118, s62, v8
    s_cmp_eq_u32 s7, 0
    s_cselect_b64 s[40:41], s[12:13], s[22:23]
    s_mov_b32 s42, 0x62000
    s_mov_b32 s43, 0x20000
    s_bfe_u32 s62, s3, 0x20001
    s_and_b32 s63, s3, 1
    s_mul_i32 s63, s63, 3
    s_mul_i32 s4, s62, 100352
    s_mul_i32 s5, s63, 7168
    s_add_u32 s4, s4, s5
    s_lshr_b32 s5, s3, 1
    s_mul_i32 s5, s5, 7
    s_add_u32 s5, s5, s63
    s_lshl_b32 s5, s5, 10
    s_add_u32 s5, s5, 98304
    s_and_b32 s11, s3, 3
    s_bfe_u32 s14, s3, 0x10002
    s_and_b32 s62, s34, 1
    s_xor_b32 s14, s14, s62
    s_lshl_b32 s10, s11, 15
    s_lshl_b32 s62, s14, 14
    s_add_u32 s10, s10, s62
    s_cmp_eq_u32 s7, 0
    s_cselect_b32 s10, s10, 0
    s_lshl_b32 s62, s32, 17
    s_add_u32 s10, s10, s62
    s_add_u32 s10, s10, 0x500000
    s_mul_i32 s15, s14, 53248
    s_sub_u32 s15, s15, 98304
    s_mul_i32 s16, s14, 59392
    s_mul_i32 s17, s14, 0xfffe0400
    s_and_b32 s19, s3, 7
    s_lshl_b32 s18, s19, 10
    s_mul_i32 s19, s19, 7168
    s_add_u32 s19, s19, 50176
    s_mov_b32 s36, s26
    s_mov_b32 s37, s27
    s_mov_b32 s38, 0x1c0000
    s_mov_b32 s39, 0x20000
    s_getreg_b32 s20, hwreg(HW_REG_XCC_ID, 0, 16)
    s_lshl_b32 s62, s33, 14
    s_add_u32 s62, s62, 0x900000
    s_and_b32 s63, s2, 7
    s_mul_i32 s63, s63, 0x8000
    s_add_u32 s62, s62, s63
    v_lshl_add_u32 v116, v0, 9, s62
    s_lshl_b32 s62, s58, 14
    v_add_u32 v2, s62, v1
    v_add_u32 v3, 0x10000, v2
    v_mov_b32 v4, 0xdddd
    s_branch FA_P0
FA_KVB_DONE:
    s_setprio 0
    s_lshr_b32 s7, s3, 3
    s_lshl_b32 s60, s7, 1
    s_and_b32 s61, s3, 1
    s_add_u32 s60, s60, s61
    s_bfe_u32 s61, s3, 0x10001
    s_lshl_b32 s62, s61, 2
    s_add_u32 s62, s62, s60
    s_lshl_b32 s62, s62, 11
    s_add_u32 s62, s62, 98304
    v_add_u32 v15, s62, v1
    s_bfe_u32 s58, s3, 0x10002
    s_lshl_b32 s62, s34, 2
    s_add_u32 s60, s60, s62
    s_lshl_b32 s62, s33, 4
    s_add_u32 s60, s60, s62
    s_lshl_b32 s62, s32, 1
    s_add_u32 s61, s61, s62
    s_lshl_b32 s73, s33, 6
    s_add_u32 s73, s73, s61
    s_lshl_b32 s73, s73, 7
    s_add_u32 s73, s73, 0x480000
    s_lshl_b32 s74, s61, 16
    s_lshl_b32 s62, s60, 10
    s_add_u32 s74, s74, s62
    s_add_u32 s74, s74, 0x500000
    s_lshl_b32 s62, s3, 11
    s_lshl_b32 s72, s33, 18
    s_add_u32 s72, s72, s62
    s_add_u32 s72, s72, 0x400000
    s_mov_b32 s59, 0
    s_mov_b32 s8, 0
    v_and_b32 v117, 7, v0
    v_lshlrev_b32 v117, 2, v117
    v_add_u32 v117, 163008, v117
    v_mov_b32 v119, 1
    s_lshl_b32 s6, s33, 2
    s_add_u32 s6, s6, s34
    v_lshrrev_b32 v8, 3, v0
    v_mul_u32_u24 v8, 896, v8
    v_bfe_u32 v9, v0, 1, 2
    v_lshrrev_b32 v10, 4, v0
    v_xor_b32 v9, v9, v10
    v_lshl_add_u32 v8, v9, 5, v8
    v_and_b32 v9, 1, v0
    v_lshl_add_u32 v8, v9, 4, v8
    s_lshl_b32 s62, s6, 7
    v_add_u32 v118, s62, v8
    s_cmp_eq_u32 s7, 0
    s_cselect_b64 s[40:41], s[12:13], s[22:23]
    s_mov_b32 s42, 0x62000
    s_mov_b32 s43, 0x20000
    s_bfe_u32 s62, s3, 0x20001
    s_and_b32 s63, s3, 1
    s_mul_i32 s63, s63, 3
    s_mul_i32 s4, s62, 100352
    s_mul_i32 s5, s63, 7168
    s_add_u32 s4, s4, s5
    s_lshr_b32 s5, s3, 1
    s_mul_i32 s5, s5, 7
    s_add_u32 s5, s5, s63
    s_lshl_b32 s5, s5, 10
    s_add_u32 s5, s5, 98304
    s_and_b32 s11, s3, 3
    s_bfe_u32 s14, s3, 0x10002
    s_and_b32 s62, s34, 1
    s_xor_b32 s14, s14, s62
    s_lshl_b32 s10, s11, 15
    s_lshl_b32 s62, s14, 14
    s_add_u32 s10, s10, s62
    s_cmp_eq_u32 s7, 0
    s_cselect_b32 s10, s10, 0
    s_lshl_b32 s62, s32, 17
    s_add_u32 s10, s10, s62
    s_add_u32 s10, s10, 0x500000
    s_mul_i32 s15, s14, 53248
    s_sub_u32 s15, s15, 98304
    s_mul_i32 s16, s14, 59392
    s_mul_i32 s17, s14, 0xfffe0400
    s_and_b32 s19, s3, 7
    s_lshl_b32 s18, s19, 10
    s_mul_i32 s19, s19, 7168
    s_add_u32 s19, s19, 50176
    s_mov_b32 s36, s26
    s_mov_b32 s37, s27
    s_mov_b32 s38, 0x1c0000
    s_mov_b32 s39, 0x20000
    s_getreg_b32 s20, hwreg(HW_REG_XCC_ID, 0, 16)
    s_lshl_b32 s62, s33, 14
    s_add_u32 s62, s62, 0x900000
    s_and_b32 s63, s2, 7
    s_mul_i32 s63, s63, 0x8000
    s_add_u32 s62, s62, s63
    v_lshl_add_u32 v116, v0, 9, s62
    s_lshl_b32 s62, s58, 14
    v_add_u32 v2, s62, v1
    v_add_u32 v3, 0x10000, v2
    v_mov_b32 v4, 0xdddd
    s_setprio 3
    v_lshlrev_b32 v8, 7, v0
    s_lshl_b32 s61, s33, 14
    s_add_u32 s61, s61, 0x900000
    s_and_b32 s60, s2, 7
    s_mul_i32 s60, s60, 0x8000
    s_add_u32 s61, s61, s60
    v_add_u32 v113, s61, v8
    s_mov_b32 s75, 0x40000
FA_SP20:
    ds_read_b32 v124, v7 offset:64
    s_waitcnt lgkmcnt(0)
    v_cmp_le_u32 vcc, 1, v124
    s_sub_u32 s75, s75, 1
    s_cbranch_scc1 FA_SX20
    s_and_b32 s70, vcc_lo, 0x21
    s_cmp_eq_u32 s70, 0x21
    s_cbranch_scc0 FA_SP20
FA_SX20:
    v_readfirstlane_b32 s56, v124
    s_mov_b32 s75, 0x40000
FA_SP21:
    ds_read_b32 v124, v7 offset:32
    s_waitcnt lgkmcnt(0)
    v_cmp_le_u32 vcc, 1, v124
    s_sub_u32 s75, s75, 1
    s_cbranch_scc1 FA_SX21
    s_cmp_eq_u64 vcc, -1
    s_cbranch_scc0 FA_SP21
FA_SX21:
    s_lshl_b32 s60, s3, 12
    s_lshl_b32 s61, s33, 18
    s_add_u32 s61, s60, s61
    s_add_u32 s55, s61, 0x400000
    s_mov_b32 m0, s60
    s_mov_b32 s75, 40000
    s_mov_b32 exec_hi, 0
FA_POLL:
    buffer_load_dword v114, v113, s[44:47], 0 offen sc1
    s_sub_u32 s75, s75, 1
    s_cbranch_scc1 FA_POLLX
    s_waitcnt vmcnt(0)
    v_cmp_eq_u32 vcc, s56, v114
    s_cmp_eq_u32 vcc_lo, -1
    s_cbranch_scc0 FA_POLL
FA_POLLX:
    s_mov_b32 exec_hi, -1
    s_mov_b64 exec, 64
    v_mov_b32 v125, 1
    ds_write_b32 v7, v125 offset:64
    s_mov_b64 exec, -1
    s_setprio 0
    s_branch FA_P1
FA_P0:
    s_mov_b32 s75, 0x40000
FA_SP22:
    ds_read_b32 v124, v7 offset:32
    s_waitcnt lgkmcnt(0)
    v_cmp_le_u32 vcc, 1, v124
    s_sub_u32 s75, s75, 1
    s_cbranch_scc1 FA_SX22
    s_cmp_eq_u64 vcc, -1
    s_cbranch_scc0 FA_SP22
FA_SX22:
    s_lshl_b32 s60, s3, 12
    s_lshl_b32 s61, s33, 18
    s_add_u32 s61, s60, s61
    s_add_u32 s55, s61, 0x400000
    s_mov_b32 m0, s60
    s_mov_b32 s75, 0x40000
FA_SP23:
    ds_read_b32 v124, v7 offset:64
    s_waitcnt lgkmcnt(0)
    v_cmp_le_u32 vcc, 1, v124
    s_sub_u32 s75, s75, 1
    s_cbranch_scc1 FA_SX23
    s_and_b32 s70, vcc_lo, 0x40
    s_cmp_eq_u32 s70, 0x40
    s_cbranch_scc0 FA_SP23
FA_SX23:
FA_P1:
    buffer_load_dwordx4 v1, s[44:47], s55 offen sc1 lds
    buffer_load_dwordx4 v1, s[44:47], s55 offen offset:1024 sc1 lds
    buffer_load_dwordx4 v1, s[44:47], s55 offen offset:2048 sc1 lds
    buffer_load_dwordx4 v1, s[44:47], s55 offen offset:3072 sc1 lds
    v_and_b32 v8, 15, v0
    v_lshrrev_b32 v9, 5, v0
    v_lshl_add_u32 v8, v9, 4, v8
    s_bfe_u32 s62, s3, 0x10002
    s_lshl_b32 s62, s62, 5
    v_add_u32 v8, s62, v8
    v_lshlrev_b32 v8, 4, v8
    v_bfe_u32 v9, v0, 4, 1
    v_lshl_add_u32 v123, v9, 15, v8
    v_lshrrev_b32 v11, 4, v0
    v_bfe_u32 v12, v0, 2, 2
    v_lshl_add_u32 v8, v11, 2, v12
    v_min_u32 v12, 2, v12
    v_mad_u32_u24 v9, v11, 3, v12
    v_add_u32 v9, 16, v9
    v_and_b32 v10, 3, v0
    v_lshlrev_b32 v10, 3, v10
    s_bfe_u32 s61, s3, 0x10002
    s_and_b32 s62, s34, 1
    s_xor_b32 s61, s61, s62
    s_mul_i32 s62, s61, 28672
    s_add_u32 s62, s62, 98304
    s_lshl_b32 s61, s61, 6
    v_bfe_u32 v11, v8, 1, 2
    v_lshlrev_b32 v11, 5, v11
    v_xor_b32 v11, s61, v11
    v_lshl_add_u32 v12, v8, 7, v10
    v_add3_u32 v120, v11, v12, s62
    v_bfe_u32 v11, v9, 1, 2
    v_lshlrev_b32 v11, 5, v11
    v_xor_b32 v11, s61, v11
    v_lshl_add_u32 v12, v9, 7, v10
    v_add3_u32 v121, v11, v12, s62
    s_mov_b32 s57, -1
    s_cmp_eq_u32 s3, 0
    s_cselect_b32 s57, 0xff, s57
    s_waitcnt vmcnt(0)
    s_waitcnt lgkmcnt(0)
FA_XY:
    s_barrier
    ds_read_b128 v[16:19], v15
    ds_read_b128 v[20:23], v15 offset:1024
FA_RESTART:
    ds_read_b32 v14, v7 offset:64
    ds_read_b128 v[92:95], v2 offset:0
    ds_read_b128 v[96:99], v2 offset:1024
    ds_read_b128 v[76:79], v2 offset:4096
    ds_read_b128 v[80:83], v2 offset:5120
    ds_read_b128 v[84:87], v2 offset:2048
    s_lshl_b32 s62, s3, 11
    s_add_u32 m0, s62, 32768
    s_add_u32 s63, s72, 32768
    buffer_load_dwordx4 v1, s[44:47], s63 offen sc1 lds
    buffer_load_dwordx4 v1, s[44:47], s63 offen offset:1024 sc1 lds
    s_cmp_eq_u32 s57, -1
    s_cbranch_scc1 FA_FRp
    s_mov_b32 exec_hi, 0
    buffer_load_dword v112, v116, s[44:47], 0 offen sc1
    buffer_load_dword v113, v116, s[44:47], 0 offen offset:128 sc1
    buffer_load_dword v114, v116, s[44:47], 0 offen offset:256 sc1
    buffer_load_dword v115, v116, s[44:47], 0 offen offset:384 sc1
    s_mov_b32 exec_hi, -1
FA_FRp:
    v_mov_b64 v[24:25], 0
    v_mov_b64 v[26:27], 0
    v_mov_b64 v[28:29], 0
    v_mov_b64 v[30:31], 0
    v_mov_b64 v[32:33], 0
    v_mov_b64 v[34:35], 0
    v_mov_b64 v[36:37], 0
    v_mov_b64 v[38:39], 0
    s_waitcnt lgkmcnt(3)
    v_mfma_f32_32x32x16_bf16 v[40:55], v[92:95], v[16:19], 0
    v_mfma_f32_32x32x16_bf16 v[40:55], v[96:99], v[20:23], v[40:55]
    v_readfirstlane_b32 s56, v14
    v_and_b32 v8, 1, v0
    v_lshlrev_b32 v8, 4, v8
    v_sub_u32 v8, 16, v8
    v_lshlrev_b32 v8, v8, s56
    v_and_b32 v126, 0xffff0000, v8
    s_nop 3
    s_waitcnt lgkmcnt(0)
    s_setprio 1
    ds_read_b128 v[88:91], v2 offset:3072
    v_exp_f32 v40, v40
    v_exp_f32 v41, v41
    v_exp_f32 v42, v42
    v_exp_f32 v43, v43
    ds_read_b128 v[92:95], v2 offset:8192
    v_mfma_f32_32x32x16_bf16 v[56:71], v[76:79], v[16:19], 0
    v_exp_f32 v44, v44
    v_exp_f32 v45, v45
    v_exp_f32 v46, v46
    v_exp_f32 v47, v47
    ds_read_b128 v[96:99], v2 offset:9216
    v_mfma_f32_32x32x16_bf16 v[56:71], v[80:83], v[20:23], v[56:71]
    v_exp_f32 v48, v48
    v_exp_f32 v49, v49
    v_exp_f32 v50, v50
    v_exp_f32 v51, v51
    ds_read_b128 v[100:103], v2 offset:6144
    v_smfmac_f32_32x32x32_bf16 v[24:39], v[84:87], v[40:47], v4
    v_exp_f32 v52, v52
    v_exp_f32 v53, v53
    v_exp_f32 v54, v54
    v_exp_f32 v55, v55
    s_waitcnt lgkmcnt(0)
    s_setprio 0
    ds_read_b128 v[72:75], v2 offset:7168
    v_smfmac_f32_32x32x32_bf16 v[24:39], v[88:91], v[48:55], v4
    v_exp_f32 v56, v56
    v_exp_f32 v57, v57
    v_exp_f32 v58, v58
    v_exp_f32 v59, v59
    ds_read_b128 v[76:79], v2 offset:12288
    v_mfma_f32_32x32x16_bf16 v[40:55], v[92:95], v[16:19], 0
    v_exp_f32 v60, v60
    v_exp_f32 v61, v61
    v_exp_f32 v62, v62
    v_exp_f32 v63, v63
    ds_read_b128 v[80:83], v2 offset:13312
    v_mfma_f32_32x32x16_bf16 v[40:55], v[96:99], v[20:23], v[40:55]
    v_exp_f32 v64, v64
    v_exp_f32 v65, v65
    v_exp_f32 v66, v66
    v_exp_f32 v67, v67
    ds_read_b128 v[84:87], v2 offset:10240
    v_smfmac_f32_32x32x32_bf16 v[24:39], v[100:103], v[56:63], v4
    v_exp_f32 v68, v68
    v_exp_f32 v69, v69
    v_exp_f32 v70, v70
    v_exp_f32 v71, v71
    s_waitcnt vmcnt(0)
    s_cmp_eq_u32 s57, -1
    s_cbranch_scc1 FA_FC2
    s_mov_b32 s52, 40000
FA_FL2:
    s_mov_b32 exec_hi, 0
    v_cmp_eq_u32 s[64:65], s56, v112
    v_cmp_eq_u32 s[66:67], s56, v113
    v_cmp_eq_u32 s[68:69], s56, v114
    v_cmp_eq_u32 vcc, s56, v115
    s_mov_b32 exec_hi, -1
    s_and_b32 s64, s64, s66
    s_and_b32 s68, s68, vcc_lo
    s_and_b32 s64, s64, s68
    s_or_b32 s57, s57, s64
    s_bfe_u32 s63, s57, 0x40008
    s_cmp_eq_u32 s63, 15
    s_cbranch_scc1 FA_FC2
    s_sub_u32 s52, s52, 1
    s_cmp_eq_u32 s52, 0
    s_cbranch_scc1 FA_FC2
    s_mov_b32 exec_hi, 0
    buffer_load_dword v112, v116, s[44:47], 0 offen sc1
    buffer_load_dword v113, v116, s[44:47], 0 offen offset:128 sc1
    buffer_load_dword v114, v116, s[44:47], 0 offen offset:256 sc1
    buffer_load_dword v115, v116, s[44:47], 0 offen offset:384 sc1
    s_mov_b32 exec_hi, -1
    s_waitcnt vmcnt(0)
    s_branch FA_FL2
FA_FC2:
    s_waitcnt lgkmcnt(0)
    s_barrier
    s_lshl_b32 s62, s3, 11
    s_add_u32 m0, s62, 65536
    s_add_u32 s63, s72, 65536
    buffer_load_dwordx4 v1, s[44:47], s63 offen sc1 lds
    buffer_load_dwordx4 v1, s[44:47], s63 offen offset:1024 sc1 lds
    s_cmp_eq_u32 s57, -1
    s_cbranch_scc1 FA_FR0
    s_mov_b32 exec_hi, 0
    buffer_load_dword v112, v116, s[44:47], 0 offen sc1
    buffer_load_dword v113, v116, s[44:47], 0 offen offset:128 sc1
    buffer_load_dword v114, v116, s[44:47], 0 offen offset:256 sc1
    buffer_load_dword v115, v116, s[44:47], 0 offen offset:384 sc1
    s_mov_b32 exec_hi, -1
FA_FR0:
    s_setprio 3
    ds_read_b128 v[88:91], v2 offset:11264
    v_smfmac_f32_32x32x32_bf16 v[24:39], v[72:75], v[64:71], v4
    v_exp_f32 v40, v40
    v_exp_f32 v41, v41
    v_exp_f32 v42, v42
    v_exp_f32 v43, v43
    ds_read_b128 v[92:95], v2 offset:32768
    v_mfma_f32_32x32x16_bf16 v[56:71], v[76:79], v[16:19], 0
    v_exp_f32 v44, v44
    v_exp_f32 v45, v45
    v_exp_f32 v46, v46
    v_exp_f32 v47, v47
    ds_read_b128 v[96:99], v2 offset:33792
    v_mfma_f32_32x32x16_bf16 v[56:71], v[80:83], v[20:23], v[56:71]
    v_exp_f32 v48, v48
    v_exp_f32 v49, v49
    v_exp_f32 v50, v50
    v_exp_f32 v51, v51
    ds_read_b128 v[100:103], v2 offset:14336
    v_smfmac_f32_32x32x32_bf16 v[24:39], v[84:87], v[40:47], v4
    v_exp_f32 v52, v52
    v_exp_f32 v53, v53
    v_exp_f32 v54, v54
    v_exp_f32 v55, v55
    s_waitcnt lgkmcnt(0)
    s_setprio 2
    ds_read_b128 v[72:75], v2 offset:15360
    v_smfmac_f32_32x32x32_bf16 v[24:39], v[88:91], v[48:55], v4
    v_exp_f32 v56, v56
    v_exp_f32 v57, v57
    v_exp_f32 v58, v58
    v_exp_f32 v59, v59
    ds_read_b128 v[76:79], v2 offset:36864
    v_mfma_f32_32x32x16_bf16 v[40:55], v[92:95], v[16:19], 0
    v_exp_f32 v60, v60
    v_exp_f32 v61, v61
    v_exp_f32 v62, v62
    v_exp_f32 v63, v63
    ds_read_b128 v[80:83], v2 offset:37888
    v_mfma_f32_32x32x16_bf16 v[40:55], v[96:99], v[20:23], v[40:55]
    v_exp_f32 v64, v64
    v_exp_f32 v65, v65
    v_exp_f32 v66, v66
    v_exp_f32 v67, v67
    ds_read_b128 v[84:87], v2 offset:34816
    v_smfmac_f32_32x32x32_bf16 v[24:39], v[100:103], v[56:63], v4
    v_exp_f32 v68, v68
    v_exp_f32 v69, v69
    v_exp_f32 v70, v70
    v_exp_f32 v71, v71
    s_waitcnt lgkmcnt(0)
    s_setprio 1
    ds_read_b128 v[88:91], v2 offset:35840
    v_smfmac_f32_32x32x32_bf16 v[24:39], v[72:75], v[64:71], v4
    v_exp_f32 v40, v40
    v_exp_f32 v41, v41
    v_exp_f32 v42, v42
    v_exp_f32 v43, v43
    ds_read_b128 v[92:95], v2 offset:40960
    v_mfma_f32_32x32x16_bf16 v[56:71], v[76:79], v[16:19], 0
    v_exp_f32 v44, v44
    v_exp_f32 v45, v45
    v_exp_f32 v46, v46
    v_exp_f32 v47, v47
    ds_read_b128 v[96:99], v2 offset:41984
    v_mfma_f32_32x32x16_bf16 v[56:71], v[80:83], v[20:23], v[56:71]
    v_exp_f32 v48, v48
    v_exp_f32 v49, v49
    v_exp_f32 v50, v50
    v_exp_f32 v51, v51
    ds_read_b128 v[100:103], v2 offset:38912
    v_smfmac_f32_32x32x32_bf16 v[24:39], v[84:87], v[40:47], v4
    v_exp_f32 v52, v52
    v_exp_f32 v53, v53
    v_exp_f32 v54, v54
    v_exp_f32 v55, v55
    s_waitcnt vmcnt(0)
    s_cmp_eq_u32 s57, -1
    s_cbranch_scc1 FA_FC3
    s_mov_b32 s52, 40000
FA_FL3:
    s_mov_b32 exec_hi, 0
    v_cmp_eq_u32 s[64:65], s56, v112
    v_cmp_eq_u32 s[66:67], s56, v113
    v_cmp_eq_u32 s[68:69], s56, v114
    v_cmp_eq_u32 vcc, s56, v115
    s_mov_b32 exec_hi, -1
    s_and_b32 s64, s64, s66
    s_and_b32 s68, s68, vcc_lo
    s_and_b32 s64, s64, s68
    s_or_b32 s57, s57, s64
    s_bfe_u32 s63, s57, 0x4000c
    s_cmp_eq_u32 s63, 15
    s_cbranch_scc1 FA_FC3
    s_sub_u32 s52, s52, 1
    s_cmp_eq_u32 s52, 0
    s_cbranch_scc1 FA_FC3
    s_mov_b32 exec_hi, 0
    buffer_load_dword v112, v116, s[44:47], 0 offen sc1
    buffer_load_dword v113, v116, s[44:47], 0 offen offset:128 sc1
    buffer_load_dword v114, v116, s[44:47], 0 offen offset:256 sc1
    buffer_load_dword v115, v116, s[44:47], 0 offen offset:384 sc1
    s_mov_b32 exec_hi, -1
    s_waitcnt vmcnt(0)
    s_branch FA_FL3
FA_FC3:
    s_waitcnt lgkmcnt(0)
    s_setprio 0
    ds_read_b128 v[72:75], v2 offset:39936
    v_smfmac_f32_32x32x32_bf16 v[24:39], v[88:91], v[48:55], v4
    v_exp_f32 v56, v56
    v_exp_f32 v57, v57
    v_exp_f32 v58, v58
    v_exp_f32 v59, v59
    ds_read_b128 v[76:79], v2 offset:45056
    v_mfma_f32_32x32x16_bf16 v[40:55], v[92:95], v[16:19], 0
    v_exp_f32 v60, v60
    v_exp_f32 v61, v61
    v_exp_f32 v62, v62
    v_exp_f32 v63, v63
    ds_read_b128 v[80:83], v2 offset:46080
    v_mfma_f32_32x32x16_bf16 v[40:55], v[96:99], v[20:23], v[40:55]
    v_exp_f32 v64, v64
    v_exp_f32 v65, v65
    v_exp_f32 v66, v66
    v_exp_f32 v67, v67
    ds_read_b128 v[84:87], v2 offset:43008
    v_smfmac_f32_32x32x32_bf16 v[24:39], v[100:103], v[56:63], v4
    v_exp_f32 v68, v68
    v_exp_f32 v69, v69
    v_exp_f32 v70, v70
    v_exp_f32 v71, v71
    s_waitcnt lgkmcnt(0)
    s_barrier
    s_lshl_b32 s62, s3, 11
    s_add_u32 m0, s62, 0
    s_add_u32 s63, s72, 98304
    buffer_load_dwordx4 v1, s[44:47], s63 offen sc1 lds
    buffer_load_dwordx4 v1, s[44:47], s63 offen offset:1024 sc1 lds
    s_cmp_eq_u32 s57, -1
    s_cbranch_scc1 FA_FR1
    s_mov_b32 exec_hi, 0
    buffer_load_dword v112, v116, s[44:47], 0 offen sc1
    buffer_load_dword v113, v116, s[44:47], 0 offen offset:128 sc1
    buffer_load_dword v114, v116, s[44:47], 0 offen offset:256 sc1
    buffer_load_dword v115, v116, s[44:47], 0 offen offset:384 sc1
    s_mov_b32 exec_hi, -1
FA_FR1:
    s_setprio 3
    ds_read_b128 v[88:91], v2 offset:44032
    v_smfmac_f32_32x32x32_bf16 v[24:39], v[72:75], v[64:71], v4
    v_exp_f32 v40, v40
    v_exp_f32 v41, v41
    v_exp_f32 v42, v42
    v_exp_f32 v43, v43
    ds_read_b128 v[92:95], v3 offset:0
    v_mfma_f32_32x32x16_bf16 v[56:71], v[76:79], v[16:19], 0
    v_exp_f32 v44, v44
    v_exp_f32 v45, v45
    v_exp_f32 v46, v46
    v_exp_f32 v47, v47
    ds_read_b128 v[96:99], v3 offset:1024
    v_mfma_f32_32x32x16_bf16 v[56:71], v[80:83], v[20:23], v[56:71]
    v_exp_f32 v48, v48
    v_exp_f32 v49, v49
    v_exp_f32 v50, v50
    v_exp_f32 v51, v51
    ds_read_b128 v[100:103], v2 offset:47104
    v_smfmac_f32_32x32x32_bf16 v[24:39], v[84:87], v[40:47], v4
    v_exp_f32 v52, v52
    v_exp_f32 v53, v53
    v_exp_f32 v54, v54
    v_exp_f32 v55, v55
    s_waitcnt lgkmcnt(0)
    s_setprio 2
    ds_read_b128 v[72:75], v2 offset:48128
    v_smfmac_f32_32x32x32_bf16 v[24:39], v[88:91], v[48:55], v4
    v_exp_f32 v56, v56
    v_exp_f32 v57, v57
    v_exp_f32 v58, v58
    v_exp_f32 v59, v59
    ds_read_b128 v[76:79], v3 offset:4096
    v_mfma_f32_32x32x16_bf16 v[40:55], v[92:95], v[16:19], 0
    v_exp_f32 v60, v60
    v_exp_f32 v61, v61
    v_exp_f32 v62, v62
    v_exp_f32 v63, v63
    ds_read_b128 v[80:83], v3 offset:5120
    v_mfma_f32_32x32x16_bf16 v[40:55], v[96:99], v[20:23], v[40:55]
    v_exp_f32 v64, v64
    v_exp_f32 v65, v65
    v_exp_f32 v66, v66
    v_exp_f32 v67, v67
    ds_read_b128 v[84:87], v3 offset:2048
    v_smfmac_f32_32x32x32_bf16 v[24:39], v[100:103], v[56:63], v4
    v_exp_f32 v68, v68
    v_exp_f32 v69, v69
    v_exp_f32 v70, v70
    v_exp_f32 v71, v71
    s_waitcnt lgkmcnt(0)
    s_setprio 1
    ds_read_b128 v[88:91], v3 offset:3072
    v_smfmac_f32_32x32x32_bf16 v[24:39], v[72:75], v[64:71], v4
    v_exp_f32 v40, v40
    v_exp_f32 v41, v41
    v_exp_f32 v42, v42
    v_exp_f32 v43, v43
    ds_read_b128 v[92:95], v3 offset:8192
    v_mfma_f32_32x32x16_bf16 v[56:71], v[76:79], v[16:19], 0
    v_exp_f32 v44, v44
    v_exp_f32 v45, v45
    v_exp_f32 v46, v46
    v_exp_f32 v47, v47
    ds_read_b128 v[96:99], v3 offset:9216
    v_mfma_f32_32x32x16_bf16 v[56:71], v[80:83], v[20:23], v[56:71]
    v_exp_f32 v48, v48
    v_exp_f32 v49, v49
    v_exp_f32 v50, v50
    v_exp_f32 v51, v51
    ds_read_b128 v[100:103], v3 offset:6144
    v_smfmac_f32_32x32x32_bf16 v[24:39], v[84:87], v[40:47], v4
    v_exp_f32 v52, v52
    v_exp_f32 v53, v53
    v_exp_f32 v54, v54
    v_exp_f32 v55, v55
    s_waitcnt vmcnt(0)
    s_cmp_eq_u32 s57, -1
    s_cbranch_scc1 FA_FC4
    s_mov_b32 s52, 40000
FA_FL4:
    s_mov_b32 exec_hi, 0
    v_cmp_eq_u32 s[64:65], s56, v112
    v_cmp_eq_u32 s[66:67], s56, v113
    v_cmp_eq_u32 s[68:69], s56, v114
    v_cmp_eq_u32 vcc, s56, v115
    s_mov_b32 exec_hi, -1
    s_and_b32 s64, s64, s66
    s_and_b32 s68, s68, vcc_lo
    s_and_b32 s64, s64, s68
    s_or_b32 s57, s57, s64
    s_bfe_u32 s63, s57, 0x40010
    s_cmp_eq_u32 s63, 15
    s_cbranch_scc1 FA_FC4
    s_sub_u32 s52, s52, 1
    s_cmp_eq_u32 s52, 0
    s_cbranch_scc1 FA_FC4
    s_mov_b32 exec_hi, 0
    buffer_load_dword v112, v116, s[44:47], 0 offen sc1
    buffer_load_dword v113, v116, s[44:47], 0 offen offset:128 sc1
    buffer_load_dword v114, v116, s[44:47], 0 offen offset:256 sc1
    buffer_load_dword v115, v116, s[44:47], 0 offen offset:384 sc1
    s_mov_b32 exec_hi, -1
    s_waitcnt vmcnt(0)
    s_branch FA_FL4
FA_FC4:
    s_waitcnt lgkmcnt(0)
    s_setprio 0
    ds_read_b128 v[72:75], v3 offset:7168
    v_smfmac_f32_32x32x32_bf16 v[24:39], v[88:91], v[48:55], v4
    v_exp_f32 v56, v56
    v_exp_f32 v57, v57
    v_exp_f32 v58, v58
    v_exp_f32 v59, v59
    ds_read_b128 v[76:79], v3 offset:12288
    v_mfma_f32_32x32x16_bf16 v[40:55], v[92:95], v[16:19], 0
    v_exp_f32 v60, v60
    v_exp_f32 v61, v61
    v_exp_f32 v62, v62
    v_exp_f32 v63, v63
    ds_read_b128 v[80:83], v3 offset:13312
    v_mfma_f32_32x32x16_bf16 v[40:55], v[96:99], v[20:23], v[40:55]
    v_exp_f32 v64, v64
    v_exp_f32 v65, v65
    v_exp_f32 v66, v66
    v_exp_f32 v67, v67
    ds_read_b128 v[84:87], v3 offset:10240
    v_smfmac_f32_32x32x32_bf16 v[24:39], v[100:103], v[56:63], v4
    v_exp_f32 v68, v68
    v_exp_f32 v69, v69
    v_exp_f32 v70, v70
    v_exp_f32 v71, v71
    s_waitcnt lgkmcnt(0)
    s_barrier
    s_lshl_b32 s62, s3, 11
    s_add_u32 m0, s62, 32768
    s_add_u32 s63, s72, 131072
    buffer_load_dwordx4 v1, s[44:47], s63 offen sc1 lds
    buffer_load_dwordx4 v1, s[44:47], s63 offen offset:1024 sc1 lds
    s_cmp_eq_u32 s57, -1
    s_cbranch_scc1 FA_FR2
    s_mov_b32 exec_hi, 0
    buffer_load_dword v112, v116, s[44:47], 0 offen sc1
    buffer_load_dword v113, v116, s[44:47], 0 offen offset:128 sc1
    buffer_load_dword v114, v116, s[44:47], 0 offen offset:256 sc1
    buffer_load_dword v115, v116, s[44:47], 0 offen offset:384 sc1
    s_mov_b32 exec_hi, -1
FA_FR2:
    s_add_u32 m0, s5, 0
    s_add_u32 s63, s4, 0
    buffer_load_dwordx4 v118, s[40:43], s63 offen lds
    s_add_u32 m0, s5, 1024
    s_add_u32 s63, s4, 7168
    buffer_load_dwordx4 v118, s[40:43], s63 offen lds
    s_setprio 3
    ds_read_b128 v[88:91], v3 offset:11264
    v_smfmac_f32_32x32x32_bf16 v[24:39], v[72:75], v[64:71], v4
    v_exp_f32 v40, v40
    v_exp_f32 v41, v41
    v_exp_f32 v42, v42
    v_exp_f32 v43, v43
    ds_read_b128 v[92:95], v2 offset:0
    v_mfma_f32_32x32x16_bf16 v[56:71], v[76:79], v[16:19], 0
    v_exp_f32 v44, v44
    v_exp_f32 v45, v45
    v_exp_f32 v46, v46
    v_exp_f32 v47, v47
    ds_read_b128 v[96:99], v2 offset:1024
    v_mfma_f32_32x32x16_bf16 v[56:71], v[80:83], v[20:23], v[56:71]
    v_exp_f32 v48, v48
    v_exp_f32 v49, v49
    v_exp_f32 v50, v50
    v_exp_f32 v51, v51
    ds_read_b128 v[100:103], v3 offset:14336
    v_smfmac_f32_32x32x32_bf16 v[24:39], v[84:87], v[40:47], v4
    v_exp_f32 v52, v52
    v_exp_f32 v53, v53
    v_exp_f32 v54, v54
    v_exp_f32 v55, v55
    s_waitcnt lgkmcnt(0)
    s_setprio 2
    ds_read_b128 v[72:75], v3 offset:15360
    v_smfmac_f32_32x32x32_bf16 v[24:39], v[88:91], v[48:55], v4
    v_exp_f32 v56, v56
    v_exp_f32 v57, v57
    v_exp_f32 v58, v58
    v_exp_f32 v59, v59
    ds_read_b128 v[76:79], v2 offset:4096
    v_mfma_f32_32x32x16_bf16 v[40:55], v[92:95], v[16:19], 0
    v_exp_f32 v60, v60
    v_exp_f32 v61, v61
    v_exp_f32 v62, v62
    v_exp_f32 v63, v63
    ds_read_b128 v[80:83], v2 offset:5120
    v_mfma_f32_32x32x16_bf16 v[40:55], v[96:99], v[20:23], v[40:55]
    v_exp_f32 v64, v64
    v_exp_f32 v65, v65
    v_exp_f32 v66, v66
    v_exp_f32 v67, v67
    ds_read_b128 v[84:87], v2 offset:2048
    v_smfmac_f32_32x32x32_bf16 v[24:39], v[100:103], v[56:63], v4
    v_exp_f32 v68, v68
    v_exp_f32 v69, v69
    v_exp_f32 v70, v70
    v_exp_f32 v71, v71
    s_waitcnt lgkmcnt(0)
    s_setprio 1
    ds_read_b128 v[88:91], v2 offset:3072
    v_smfmac_f32_32x32x32_bf16 v[24:39], v[72:75], v[64:71], v4
    v_exp_f32 v40, v40
    v_exp_f32 v41, v41
    v_exp_f32 v42, v42
    v_exp_f32 v43, v43
    ds_read_b128 v[92:95], v2 offset:8192
    v_mfma_f32_32x32x16_bf16 v[56:71], v[76:79], v[16:19], 0
    v_exp_f32 v44, v44
    v_exp_f32 v45, v45
    v_exp_f32 v46, v46
    v_exp_f32 v47, v47
    ds_read_b128 v[96:99], v2 offset:9216
    v_mfma_f32_32x32x16_bf16 v[56:71], v[80:83], v[20:23], v[56:71]
    v_exp_f32 v48, v48
    v_exp_f32 v49, v49
    v_exp_f32 v50, v50
    v_exp_f32 v51, v51
    ds_read_b128 v[100:103], v2 offset:6144
    v_smfmac_f32_32x32x32_bf16 v[24:39], v[84:87], v[40:47], v4
    v_exp_f32 v52, v52
    v_exp_f32 v53, v53
    v_exp_f32 v54, v54
    v_exp_f32 v55, v55
    s_waitcnt vmcnt(2)
    s_cmp_eq_u32 s57, -1
    s_cbranch_scc1 FA_FC5
    s_mov_b32 s52, 40000
FA_FL5:
    s_mov_b32 exec_hi, 0
    v_cmp_eq_u32 s[64:65], s56, v112
    v_cmp_eq_u32 s[66:67], s56, v113
    v_cmp_eq_u32 s[68:69], s56, v114
    v_cmp_eq_u32 vcc, s56, v115
    s_mov_b32 exec_hi, -1
    s_and_b32 s64, s64, s66
    s_and_b32 s68, s68, vcc_lo
    s_and_b32 s64, s64, s68
    s_or_b32 s57, s57, s64
    s_bfe_u32 s63, s57, 0x40014
    s_cmp_eq_u32 s63, 15
    s_cbranch_scc1 FA_FC5
    s_sub_u32 s52, s52, 1
    s_cmp_eq_u32 s52, 0
    s_cbranch_scc1 FA_FC5
    s_mov_b32 exec_hi, 0
    buffer_load_dword v112, v116, s[44:47], 0 offen sc1
    buffer_load_dword v113, v116, s[44:47], 0 offen offset:128 sc1
    buffer_load_dword v114, v116, s[44:47], 0 offen offset:256 sc1
    buffer_load_dword v115, v116, s[44:47], 0 offen offset:384 sc1
    s_mov_b32 exec_hi, -1
    s_waitcnt vmcnt(0)
    s_branch FA_FL5
FA_FC5:
    s_waitcnt lgkmcnt(0)
    s_setprio 0
    ds_read_b128 v[72:75], v2 offset:7168
    v_smfmac_f32_32x32x32_bf16 v[24:39], v[88:91], v[48:55], v4
    v_exp_f32 v56, v56
    v_exp_f32 v57, v57
    v_exp_f32 v58, v58
    v_exp_f32 v59, v59
    ds_read_b128 v[76:79], v2 offset:12288
    v_mfma_f32_32x32x16_bf16 v[40:55], v[92:95], v[16:19], 0
    v_exp_f32 v60, v60
    v_exp_f32 v61, v61
    v_exp_f32 v62, v62
    v_exp_f32 v63, v63
    ds_read_b128 v[80:83], v2 offset:13312
    v_mfma_f32_32x32x16_bf16 v[40:55], v[96:99], v[20:23], v[40:55]
    v_exp_f32 v64, v64
    v_exp_f32 v65, v65
    v_exp_f32 v66, v66
    v_exp_f32 v67, v67
    ds_read_b128 v[84:87], v2 offset:10240
    v_smfmac_f32_32x32x32_bf16 v[24:39], v[100:103], v[56:63], v4
    v_exp_f32 v68, v68
    v_exp_f32 v69, v69
    v_exp_f32 v70, v70
    v_exp_f32 v71, v71
    s_waitcnt lgkmcnt(0)
    s_barrier
    s_lshl_b32 s62, s3, 11
    s_add_u32 m0, s62, 65536
    s_add_u32 s63, s72, 163840
    buffer_load_dwordx4 v1, s[44:47], s63 offen sc1 lds
    buffer_load_dwordx4 v1, s[44:47], s63 offen offset:1024 sc1 lds
    s_cmp_eq_u32 s57, -1
    s_cbranch_scc1 FA_FR3
    s_mov_b32 exec_hi, 0
    buffer_load_dword v112, v116, s[44:47], 0 offen sc1
    buffer_load_dword v113, v116, s[44:47], 0 offen offset:128 sc1
    buffer_load_dword v114, v116, s[44:47], 0 offen offset:256 sc1
    buffer_load_dword v115, v116, s[44:47], 0 offen offset:384 sc1
    s_mov_b32 exec_hi, -1
FA_FR3:
    s_add_u32 m0, s5, 2048
    s_add_u32 s63, s4, 14336
    buffer_load_dwordx4 v118, s[40:43], s63 offen lds
    s_add_u32 m0, s5, 3072
    s_add_u32 s63, s4, 21504
    buffer_load_dwordx4 v118, s[40:43], s63 offen lds
    s_setprio 3
    ds_read_b128 v[88:91], v2 offset:11264
    v_smfmac_f32_32x32x32_bf16 v[24:39], v[72:75], v[64:71], v4
    v_exp_f32 v40, v40
    v_exp_f32 v41, v41
    v_exp_f32 v42, v42
    v_exp_f32 v43, v43
    ds_read_b128 v[92:95], v2 offset:32768
    v_mfma_f32_32x32x16_bf16 v[56:71], v[76:79], v[16:19], 0
    v_exp_f32 v44, v44
    v_exp_f32 v45, v45
    v_exp_f32 v46, v46
    v_exp_f32 v47, v47
    ds_read_b128 v[96:99], v2 offset:33792
    v_mfma_f32_32x32x16_bf16 v[56:71], v[80:83], v[20:23], v[56:71]
    v_exp_f32 v48, v48
    v_exp_f32 v49, v49
    v_exp_f32 v50, v50
    v_exp_f32 v51, v51
    ds_read_b128 v[100:103], v2 offset:14336
    v_smfmac_f32_32x32x32_bf16 v[24:39], v[84:87], v[40:47], v4
    v_exp_f32 v52, v52
    v_exp_f32 v53, v53
    v_exp_f32 v54, v54
    v_exp_f32 v55, v55
    s_waitcnt lgkmcnt(0)
    s_setprio 2
    ds_read_b128 v[72:75], v2 offset:15360
    v_smfmac_f32_32x32x32_bf16 v[24:39], v[88:91], v[48:55], v4
    v_exp_f32 v56, v56
    v_exp_f32 v57, v57
    v_exp_f32 v58, v58
    v_exp_f32 v59, v59
    ds_read_b128 v[76:79], v2 offset:36864
    v_mfma_f32_32x32x16_bf16 v[40:55], v[92:95], v[16:19], 0
    v_exp_f32 v60, v60
    v_exp_f32 v61, v61
    v_exp_f32 v62, v62
    v_exp_f32 v63, v63
    ds_read_b128 v[80:83], v2 offset:37888
    v_mfma_f32_32x32x16_bf16 v[40:55], v[96:99], v[20:23], v[40:55]
    v_exp_f32 v64, v64
    v_exp_f32 v65, v65
    v_exp_f32 v66, v66
    v_exp_f32 v67, v67
    ds_read_b128 v[84:87], v2 offset:34816
    v_smfmac_f32_32x32x32_bf16 v[24:39], v[100:103], v[56:63], v4
    v_exp_f32 v68, v68
    v_exp_f32 v69, v69
    v_exp_f32 v70, v70
    v_exp_f32 v71, v71
    s_waitcnt lgkmcnt(0)
    s_setprio 1
    ds_read_b128 v[88:91], v2 offset:35840
    v_smfmac_f32_32x32x32_bf16 v[24:39], v[72:75], v[64:71], v4
    v_exp_f32 v40, v40
    v_exp_f32 v41, v41
    v_exp_f32 v42, v42
    v_exp_f32 v43, v43
    ds_read_b128 v[92:95], v2 offset:40960
    v_mfma_f32_32x32x16_bf16 v[56:71], v[76:79], v[16:19], 0
    v_exp_f32 v44, v44
    v_exp_f32 v45, v45
    v_exp_f32 v46, v46
    v_exp_f32 v47, v47
    ds_read_b128 v[96:99], v2 offset:41984
    v_mfma_f32_32x32x16_bf16 v[56:71], v[80:83], v[20:23], v[56:71]
    v_exp_f32 v48, v48
    v_exp_f32 v49, v49
    v_exp_f32 v50, v50
    v_exp_f32 v51, v51
    ds_read_b128 v[100:103], v2 offset:38912
    v_smfmac_f32_32x32x32_bf16 v[24:39], v[84:87], v[40:47], v4
    v_exp_f32 v52, v52
    v_exp_f32 v53, v53
    v_exp_f32 v54, v54
    v_exp_f32 v55, v55
    s_waitcnt vmcnt(2)
    s_cmp_eq_u32 s57, -1
    s_cbranch_scc1 FA_FC6
    s_mov_b32 s52, 40000
FA_FL6:
    s_mov_b32 exec_hi, 0
    v_cmp_eq_u32 s[64:65], s56, v112
    v_cmp_eq_u32 s[66:67], s56, v113
    v_cmp_eq_u32 s[68:69], s56, v114
    v_cmp_eq_u32 vcc, s56, v115
    s_mov_b32 exec_hi, -1
    s_and_b32 s64, s64, s66
    s_and_b32 s68, s68, vcc_lo
    s_and_b32 s64, s64, s68
    s_or_b32 s57, s57, s64
    s_bfe_u32 s63, s57, 0x40018
    s_cmp_eq_u32 s63, 15
    s_cbranch_scc1 FA_FC6
    s_sub_u32 s52, s52, 1
    s_cmp_eq_u32 s52, 0
    s_cbranch_scc1 FA_FC6
    s_mov_b32 exec_hi, 0
    buffer_load_dword v112, v116, s[44:47], 0 offen sc1
    buffer_load_dword v113, v116, s[44:47], 0 offen offset:128 sc1
    buffer_load_dword v114, v116, s[44:47], 0 offen offset:256 sc1
    buffer_load_dword v115, v116, s[44:47], 0 offen offset:384 sc1
    s_mov_b32 exec_hi, -1
    s_waitcnt vmcnt(0)
    s_branch FA_FL6
FA_FC6:
    s_waitcnt lgkmcnt(0)
    s_setprio 0
    ds_read_b128 v[72:75], v2 offset:39936
    v_smfmac_f32_32x32x32_bf16 v[24:39], v[88:91], v[48:55], v4
    v_exp_f32 v56, v56
    v_exp_f32 v57, v57
    v_exp_f32 v58, v58
    v_exp_f32 v59, v59
    ds_read_b128 v[76:79], v2 offset:45056
    v_mfma_f32_32x32x16_bf16 v[40:55], v[92:95], v[16:19], 0
    v_exp_f32 v60, v60
    v_exp_f32 v61, v61
    v_exp_f32 v62, v62
    v_exp_f32 v63, v63
    ds_read_b128 v[80:83], v2 offset:46080
    v_mfma_f32_32x32x16_bf16 v[40:55], v[96:99], v[20:23], v[40:55]
    v_exp_f32 v64, v64
    v_exp_f32 v65, v65
    v_exp_f32 v66, v66
    v_exp_f32 v67, v67
    ds_read_b128 v[84:87], v2 offset:43008
    v_smfmac_f32_32x32x32_bf16 v[24:39], v[100:103], v[56:63], v4
    v_exp_f32 v68, v68
    v_exp_f32 v69, v69
    v_exp_f32 v70, v70
    v_exp_f32 v71, v71
    s_waitcnt lgkmcnt(0)
    s_barrier
    s_lshl_b32 s62, s3, 11
    s_add_u32 m0, s62, 0
    s_add_u32 s63, s72, 196608
    buffer_load_dwordx4 v1, s[44:47], s63 offen sc1 lds
    buffer_load_dwordx4 v1, s[44:47], s63 offen offset:1024 sc1 lds
    s_cmp_eq_u32 s57, -1
    s_cbranch_scc1 FA_FR4
    s_mov_b32 exec_hi, 0
    buffer_load_dword v112, v116, s[44:47], 0 offen sc1
    buffer_load_dword v113, v116, s[44:47], 0 offen offset:128 sc1
    buffer_load_dword v114, v116, s[44:47], 0 offen offset:256 sc1
    buffer_load_dword v115, v116, s[44:47], 0 offen offset:384 sc1
    s_mov_b32 exec_hi, -1
FA_FR4:
    s_and_b32 s63, s3, 3
    s_cmp_eq_u32 s3, 8
    s_cselect_b32 s63, 3, s63
    s_cselect_b32 s62, 0, s3
    s_cmp_lt_u32 s62, 4
    s_cbranch_scc0 FA_NPF
    s_mul_i32 s63, s63, 100352
    s_lshl_b32 s62, s6, 7
    v_mul_u32_u24 v8, 896, v0
    s_add_u32 s63, s63, 50176
    v_add_u32 v8, s62, v8
    buffer_load_dword v127, v8, s[40:43], s63 offen
FA_NPF:
    s_mov_b32 s40, s22
    s_mov_b32 s41, s23
    s_cmp_lt_u32 s3, 7
    s_cbranch_scc0 FA_WL4
    s_add_u32 m0, s18, 155648
    s_add_u32 s63, s19, 200704
    buffer_load_dwordx4 v118, s[40:43], s63 offen lds
FA_WL4:
    s_setprio 3
    ds_read_b128 v[88:91], v2 offset:44032
    v_smfmac_f32_32x32x32_bf16 v[24:39], v[72:75], v[64:71], v4
    v_exp_f32 v40, v40
    v_exp_f32 v41, v41
    v_exp_f32 v42, v42
    v_exp_f32 v43, v43
    ds_read_b128 v[92:95], v3 offset:0
    v_mfma_f32_32x32x16_bf16 v[56:71], v[76:79], v[16:19], 0
    v_exp_f32 v44, v44
    v_exp_f32 v45, v45
    v_exp_f32 v46, v46
    v_exp_f32 v47, v47
    ds_read_b128 v[96:99], v3 offset:1024
    v_mfma_f32_32x32x16_bf16 v[56:71], v[80:83], v[20:23], v[56:71]
    v_exp_f32 v48, v48
    v_exp_f32 v49, v49
    v_exp_f32 v50, v50
    v_exp_f32 v51, v51
    ds_read_b128 v[100:103], v2 offset:47104
    v_smfmac_f32_32x32x32_bf16 v[24:39], v[84:87], v[40:47], v4
    v_exp_f32 v52, v52
    v_exp_f32 v53, v53
    v_exp_f32 v54, v54
    v_exp_f32 v55, v55
    s_waitcnt lgkmcnt(0)
    s_setprio 2
    ds_read_b128 v[72:75], v2 offset:48128
    v_smfmac_f32_32x32x32_bf16 v[24:39], v[88:91], v[48:55], v4
    v_exp_f32 v56, v56
    v_exp_f32 v57, v57
    v_exp_f32 v58, v58
    v_exp_f32 v59, v59
    ds_read_b128 v[76:79], v3 offset:4096
    v_mfma_f32_32x32x16_bf16 v[40:55], v[92:95], v[16:19], 0
    v_exp_f32 v60, v60
    v_exp_f32 v61, v61
    v_exp_f32 v62, v62
    v_exp_f32 v63, v63
    ds_read_b128 v[80:83], v3 offset:5120
    v_mfma_f32_32x32x16_bf16 v[40:55], v[96:99], v[20:23], v[40:55]
    v_exp_f32 v64, v64
    v_exp_f32 v65, v65
    v_exp_f32 v66, v66
    v_exp_f32 v67, v67
    ds_read_b128 v[84:87], v3 offset:2048
    v_smfmac_f32_32x32x32_bf16 v[24:39], v[100:103], v[56:63], v4
    v_exp_f32 v68, v68
    v_exp_f32 v69, v69
    v_exp_f32 v70, v70
    v_exp_f32 v71, v71
    s_waitcnt lgkmcnt(0)
    s_setprio 1
    ds_read_b128 v[88:91], v3 offset:3072
    v_smfmac_f32_32x32x32_bf16 v[24:39], v[72:75], v[64:71], v4
    v_exp_f32 v40, v40
    v_exp_f32 v41, v41
    v_exp_f32 v42, v42
    v_exp_f32 v43, v43
    ds_read_b128 v[92:95], v3 offset:8192
    v_mfma_f32_32x32x16_bf16 v[56:71], v[76:79], v[16:19], 0
    v_exp_f32 v44, v44
    v_exp_f32 v45, v45
    v_exp_f32 v46, v46
    v_exp_f32 v47, v47
    ds_read_b128 v[96:99], v3 offset:9216
    v_mfma_f32_32x32x16_bf16 v[56:71], v[80:83], v[20:23], v[56:71]
    v_exp_f32 v48, v48
    v_exp_f32 v49, v49
    v_exp_f32 v50, v50
    v_exp_f32 v51, v51
    ds_read_b128 v[100:103], v3 offset:6144
    v_smfmac_f32_32x32x32_bf16 v[24:39], v[84:87], v[40:47], v4
    v_exp_f32 v52, v52
    v_exp_f32 v53, v53
    v_exp_f32 v54, v54
    v_exp_f32 v55, v55
    s_waitcnt vmcnt(0)
    s_cmp_eq_u32 s57, -1
    s_cbranch_scc1 FA_FC7
    s_mov_b32 s52, 40000
FA_FL7:
    s_mov_b32 exec_hi, 0
    v_cmp_eq_u32 s[64:65], s56, v112
    v_cmp_eq_u32 s[66:67], s56, v113
    v_cmp_eq_u32 s[68:69], s56, v114
    v_cmp_eq_u32 vcc, s56, v115
    s_mov_b32 exec_hi, -1
    s_and_b32 s64, s64, s66
    s_and_b32 s68, s68, vcc_lo
    s_and_b32 s64, s64, s68
    s_or_b32 s57, s57, s64
    s_bfe_u32 s63, s57, 0x4001c
    s_cmp_eq_u32 s63, 15
    s_cbranch_scc1 FA_FC7
    s_sub_u32 s52, s52, 1
    s_cmp_eq_u32 s52, 0
    s_cbranch_scc1 FA_FC7
    s_mov_b32 exec_hi, 0
    buffer_load_dword v112, v116, s[44:47], 0 offen sc1
    buffer_load_dword v113, v116, s[44:47], 0 offen offset:128 sc1
    buffer_load_dword v114, v116, s[44:47], 0 offen offset:256 sc1
    buffer_load_dword v115, v116, s[44:47], 0 offen offset:384 sc1
    s_mov_b32 exec_hi, -1
    s_waitcnt vmcnt(0)
    s_branch FA_FL7
FA_FC7:
    s_waitcnt lgkmcnt(0)
    s_setprio 0
    ds_read_b128 v[72:75], v3 offset:7168
    v_smfmac_f32_32x32x32_bf16 v[24:39], v[88:91], v[48:55], v4
    v_exp_f32 v56, v56
    v_exp_f32 v57, v57
    v_exp_f32 v58, v58
    v_exp_f32 v59, v59
    ds_read_b128 v[76:79], v3 offset:12288
    v_mfma_f32_32x32x16_bf16 v[40:55], v[92:95], v[16:19], 0
    v_exp_f32 v60, v60
    v_exp_f32 v61, v61
    v_exp_f32 v62, v62
    v_exp_f32 v63, v63
    ds_read_b128 v[80:83], v3 offset:13312
    v_mfma_f32_32x32x16_bf16 v[40:55], v[96:99], v[20:23], v[40:55]
    v_exp_f32 v64, v64
    v_exp_f32 v65, v65
    v_exp_f32 v66, v66
    v_exp_f32 v67, v67
    ds_read_b128 v[84:87], v3 offset:10240
    v_smfmac_f32_32x32x32_bf16 v[24:39], v[100:103], v[56:63], v4
    v_exp_f32 v68, v68
    v_exp_f32 v69, v69
    v_exp_f32 v70, v70
    v_exp_f32 v71, v71
    s_waitcnt lgkmcnt(0)
    s_barrier
    s_lshl_b32 s62, s3, 11
    s_add_u32 m0, s62, 32768
    s_add_u32 s63, s72, 229376
    buffer_load_dwordx4 v1, s[44:47], s63 offen sc1 lds
    buffer_load_dwordx4 v1, s[44:47], s63 offen offset:1024 sc1 lds
    s_setprio 3
    ds_read_b128 v[88:91], v3 offset:11264
    v_smfmac_f32_32x32x32_bf16 v[24:39], v[72:75], v[64:71], v4
    v_exp_f32 v40, v40
    v_exp_f32 v41, v41
    v_exp_f32 v42, v42
    v_exp_f32 v43, v43
    ds_read_b128 v[92:95], v2 offset:0
    v_mfma_f32_32x32x16_bf16 v[56:71], v[76:79], v[16:19], 0
    v_exp_f32 v44, v44
    v_exp_f32 v45, v45
    v_exp_f32 v46, v46
    v_exp_f32 v47, v47
    ds_read_b128 v[96:99], v2 offset:1024
    v_mfma_f32_32x32x16_bf16 v[56:71], v[80:83], v[20:23], v[56:71]
    v_exp_f32 v48, v48
    v_exp_f32 v49, v49
    v_exp_f32 v50, v50
    v_exp_f32 v51, v51
    ds_read_b128 v[100:103], v3 offset:14336
    v_smfmac_f32_32x32x32_bf16 v[24:39], v[84:87], v[40:47], v4
    v_exp_f32 v52, v52
    v_exp_f32 v53, v53
    v_exp_f32 v54, v54
    v_exp_f32 v55, v55
    s_waitcnt lgkmcnt(0)
    s_setprio 2
    ds_read_b128 v[72:75], v3 offset:15360
    v_smfmac_f32_32x32x32_bf16 v[24:39], v[88:91], v[48:55], v4
    v_exp_f32 v56, v56
    v_exp_f32 v57, v57
    v_exp_f32 v58, v58
    v_exp_f32 v59, v59
    ds_read_b128 v[76:79], v2 offset:4096
    v_mfma_f32_32x32x16_bf16 v[40:55], v[92:95], v[16:19], 0
    v_exp_f32 v60, v60
    v_exp_f32 v61, v61
    v_exp_f32 v62, v62
    v_exp_f32 v63, v63
    ds_read_b128 v[80:83], v2 offset:5120
    v_mfma_f32_32x32x16_bf16 v[40:55], v[96:99], v[20:23], v[40:55]
    v_exp_f32 v64, v64
    v_exp_f32 v65, v65
    v_exp_f32 v66, v66
    v_exp_f32 v67, v67
    ds_read_b128 v[84:87], v2 offset:2048
    v_smfmac_f32_32x32x32_bf16 v[24:39], v[100:103], v[56:63], v4
    v_exp_f32 v68, v68
    v_exp_f32 v69, v69
    v_exp_f32 v70, v70
    v_exp_f32 v71, v71
    s_waitcnt lgkmcnt(0)
    s_setprio 1
    ds_read_b128 v[88:91], v2 offset:3072
    v_smfmac_f32_32x32x32_bf16 v[24:39], v[72:75], v[64:71], v4
    v_exp_f32 v40, v40
    v_exp_f32 v41, v41
    v_exp_f32 v42, v42
    v_exp_f32 v43, v43
    ds_read_b128 v[92:95], v2 offset:8192
    v_mfma_f32_32x32x16_bf16 v[56:71], v[76:79], v[16:19], 0
    v_exp_f32 v44, v44
    v_exp_f32 v45, v45
    v_exp_f32 v46, v46
    v_exp_f32 v47, v47
    ds_read_b128 v[96:99], v2 offset:9216
    v_mfma_f32_32x32x16_bf16 v[56:71], v[80:83], v[20:23], v[56:71]
    v_exp_f32 v48, v48
    v_exp_f32 v49, v49
    v_exp_f32 v50, v50
    v_exp_f32 v51, v51
    ds_read_b128 v[100:103], v2 offset:6144
    v_smfmac_f32_32x32x32_bf16 v[24:39], v[84:87], v[40:47], v4
    v_exp_f32 v52, v52
    v_exp_f32 v53, v53
    v_exp_f32 v54, v54
    v_exp_f32 v55, v55
    s_waitcnt vmcnt(0)
    s_waitcnt lgkmcnt(0)
    s_setprio 0
    ds_read_b128 v[72:75], v2 offset:7168
    v_smfmac_f32_32x32x32_bf16 v[24:39], v[88:91], v[48:55], v4
    v_exp_f32 v56, v56
    v_exp_f32 v57, v57
    v_exp_f32 v58, v58
    v_exp_f32 v59, v59
    ds_read_b128 v[76:79], v2 offset:12288
    v_mfma_f32_32x32x16_bf16 v[40:55], v[92:95], v[16:19], 0
    v_exp_f32 v60, v60
    v_exp_f32 v61, v61
    v_exp_f32 v62, v62
    v_exp_f32 v63, v63
    ds_read_b128 v[80:83], v2 offset:13312
    v_mfma_f32_32x32x16_bf16 v[40:55], v[96:99], v[20:23], v[40:55]
    v_exp_f32 v64, v64
    v_exp_f32 v65, v65
    v_exp_f32 v66, v66
    v_exp_f32 v67, v67
    ds_read_b128 v[84:87], v2 offset:10240
    v_smfmac_f32_32x32x32_bf16 v[24:39], v[100:103], v[56:63], v4
    v_exp_f32 v68, v68
    v_exp_f32 v69, v69
    v_exp_f32 v70, v70
    v_exp_f32 v71, v71
    s_waitcnt lgkmcnt(0)
    s_barrier
    s_cmp_lt_u32 s3, 7
    s_cbranch_scc0 FA_WL6
    s_add_u32 m0, s18, 81920
    s_add_u32 s63, s19, 0
    buffer_load_dwordx4 v118, s[40:43], s63 offen lds
    s_add_u32 m0, s18, 89088
    s_add_u32 s63, s19, 100352
    buffer_load_dwordx4 v118, s[40:43], s63 offen lds
FA_WL6:
    v_and_b32 v8, 31, v0
    v_lshlrev_b32 v8, 2, v8
    buffer_load_dword v5, v8, s[44:47], s73 offen sc1
    v_and_b32 v9, 3, v0
    v_bfe_u32 v10, v0, 2, 1
    v_lshlrev_b32 v9, 7, v9
    s_lshl_b32 s63, s35, 9
    v_lshl_add_u32 v9, v10, 14, v9
    s_add_u32 s63, s63, 0x900000
    s_and_b32 s62, s2, 7
    s_mul_i32 s62, s62, 0x8000
    s_add_u32 s63, s63, s62
    buffer_load_dwordx2 v[112:113], v9, s[44:47], s63 offen sc1
    s_setprio 1
    s_cmp_eq_u32 s7, 0
    s_cbranch_scc0 FA_PR26
    s_setprio 3
FA_PR26:
    ds_read_b128 v[88:91], v2 offset:11264
    v_smfmac_f32_32x32x32_bf16 v[24:39], v[72:75], v[64:71], v4
    v_exp_f32 v40, v40
    v_exp_f32 v41, v41
    v_exp_f32 v42, v42
    v_exp_f32 v43, v43
    ds_read_b128 v[92:95], v2 offset:32768
    v_mfma_f32_32x32x16_bf16 v[56:71], v[76:79], v[16:19], 0
    v_exp_f32 v44, v44
    v_exp_f32 v45, v45
    v_exp_f32 v46, v46
    v_exp_f32 v47, v47
    ds_read_b128 v[96:99], v2 offset:33792
    v_mfma_f32_32x32x16_bf16 v[56:71], v[80:83], v[20:23], v[56:71]
    v_exp_f32 v48, v48
    v_exp_f32 v49, v49
    v_exp_f32 v50, v50
    v_exp_f32 v51, v51
    ds_read_b128 v[100:103], v2 offset:14336
    v_smfmac_f32_32x32x32_bf16 v[24:39], v[84:87], v[40:47], v4
    v_exp_f32 v52, v52
    v_exp_f32 v53, v53
    v_exp_f32 v54, v54
    v_exp_f32 v55, v55
    s_waitcnt lgkmcnt(0)
    ds_read_b128 v[72:75], v2 offset:15360
    v_smfmac_f32_32x32x32_bf16 v[24:39], v[88:91], v[48:55], v4
    v_exp_f32 v56, v56
    v_exp_f32 v57, v57
    v_exp_f32 v58, v58
    v_exp_f32 v59, v59
    ds_read_b128 v[76:79], v2 offset:36864
    v_mfma_f32_32x32x16_bf16 v[40:55], v[92:95], v[16:19], 0
    v_exp_f32 v60, v60
    v_exp_f32 v61, v61
    v_exp_f32 v62, v62
    v_exp_f32 v63, v63
    ds_read_b128 v[80:83], v2 offset:37888
    v_mfma_f32_32x32x16_bf16 v[40:55], v[96:99], v[20:23], v[40:55]
    v_exp_f32 v64, v64
    v_exp_f32 v65, v65
    v_exp_f32 v66, v66
    v_exp_f32 v67, v67
    ds_read_b128 v[84:87], v2 offset:34816
    v_smfmac_f32_32x32x32_bf16 v[24:39], v[100:103], v[56:63], v4
    v_exp_f32 v68, v68
    v_exp_f32 v69, v69
    v_exp_f32 v70, v70
    v_exp_f32 v71, v71
    s_waitcnt lgkmcnt(0)
    s_mov_b64 exec, 1
    ds_add_u32 v117, v119
    s_mov_b64 exec, -1
    ds_read_b128 v[88:91], v2 offset:35840
    v_smfmac_f32_32x32x32_bf16 v[24:39], v[72:75], v[64:71], v4
    v_exp_f32 v40, v40
    v_exp_f32 v41, v41
    v_exp_f32 v42, v42
    v_exp_f32 v43, v43
    ds_read_b128 v[92:95], v2 offset:40960
    v_mfma_f32_32x32x16_bf16 v[56:71], v[76:79], v[16:19], 0
    v_exp_f32 v44, v44
    v_exp_f32 v45, v45
    v_exp_f32 v46, v46
    v_exp_f32 v47, v47
    ds_read_b128 v[96:99], v2 offset:41984
    v_mfma_f32_32x32x16_bf16 v[56:71], v[80:83], v[20:23], v[56:71]
    v_exp_f32 v48, v48
    v_exp_f32 v49, v49
    v_exp_f32 v50, v50
    v_exp_f32 v51, v51
    ds_read_b128 v[100:103], v2 offset:38912
    v_smfmac_f32_32x32x32_bf16 v[24:39], v[84:87], v[40:47], v4
    v_exp_f32 v52, v52
    v_exp_f32 v53, v53
    v_exp_f32 v54, v54
    v_exp_f32 v55, v55
    s_waitcnt lgkmcnt(0)
    s_setprio 1
    s_cmp_eq_u32 s7, 0
    s_cbranch_scc0 FA_PR29
    s_setprio 2
FA_PR29:
    s_lshl_b32 s60, s18, 1
    s_add_u32 s60, s60, 65536
    s_xor_b32 s61, s60, 8192
    v_add_u32 v104, s60, v1
    v_add_u32 v105, s61, v1
    s_lshl_b32 s60, s3, 2
    s_add_u32 s60, s60, 162944
    s_xor_b32 s61, s60, 16
    v_mov_b32 v106, s60
    v_mov_b32 v107, s61
    s_mov_b32 s64, 0x30800000
    s_mov_b32 s65, 0x4e800000
    s_movk_i32 s66, 0x1f8
    s_mov_b32 s67, 0xffff
    ds_read_b128 v[72:75], v2 offset:39936
    v_smfmac_f32_32x32x32_bf16 v[24:39], v[88:91], v[48:55], v4
    v_exp_f32 v56, v56
    v_exp_f32 v57, v57
    v_exp_f32 v58, v58
    v_exp_f32 v59, v59
    ds_read_b128 v[76:79], v2 offset:45056
    v_mfma_f32_32x32x16_bf16 v[40:55], v[92:95], v[16:19], 0
    v_exp_f32 v60, v60
    v_exp_f32 v61, v61
    v_exp_f32 v62, v62
    v_exp_f32 v63, v63
    ds_read_b128 v[80:83], v2 offset:46080
    v_mfma_f32_32x32x16_bf16 v[40:55], v[96:99], v[20:23], v[40:55]
    v_exp_f32 v64, v64
    v_exp_f32 v65, v65
    v_exp_f32 v66, v66
    v_exp_f32 v67, v67
    ds_read_b128 v[84:87], v2 offset:43008
    v_smfmac_f32_32x32x32_bf16 v[24:39], v[100:103], v[56:63], v4
    v_exp_f32 v68, v68
    v_exp_f32 v69, v69
    v_exp_f32 v70, v70
    v_exp_f32 v71, v71
    s_waitcnt lgkmcnt(0)
    ds_read_b128 v[88:91], v2 offset:44032
    v_smfmac_f32_32x32x32_bf16 v[24:39], v[72:75], v[64:71], v4
    v_exp_f32 v40, v40
    v_exp_f32 v41, v41
    v_exp_f32 v42, v42
    v_exp_f32 v43, v43
    ds_read_b128 v[100:103], v2 offset:47104
    v_mfma_f32_32x32x16_bf16 v[56:71], v[76:79], v[16:19], 0
    v_exp_f32 v44, v44
    v_exp_f32 v45, v45
    v_exp_f32 v46, v46
    v_exp_f32 v47, v47
    v_mfma_f32_32x32x16_bf16 v[56:71], v[80:83], v[20:23], v[56:71]
    v_exp_f32 v48, v48
    v_exp_f32 v49, v49
    v_exp_f32 v50, v50
    v_exp_f32 v51, v51
    v_smfmac_f32_32x32x32_bf16 v[24:39], v[84:87], v[40:47], v4
    v_exp_f32 v52, v52
    v_exp_f32 v53, v53
    v_exp_f32 v54, v54
    v_exp_f32 v55, v55
    s_waitcnt lgkmcnt(0)
    ds_read_b32 v124, v117
    ds_read_b128 v[72:75], v2 offset:48128
    v_smfmac_f32_32x32x32_bf16 v[24:39], v[88:91], v[48:55], v4
    v_exp_f32 v56, v56
    v_exp_f32 v57, v57
    v_exp_f32 v58, v58
    v_exp_f32 v59, v59
    v_exp_f32 v60, v60
    v_exp_f32 v61, v61
    v_exp_f32 v62, v62
    v_exp_f32 v63, v63
    v_exp_f32 v64, v64
    v_exp_f32 v65, v65
    v_exp_f32 v66, v66
    v_exp_f32 v67, v67
    v_smfmac_f32_32x32x32_bf16 v[24:39], v[100:103], v[56:63], v4
    v_exp_f32 v68, v68
    v_exp_f32 v69, v69
    v_exp_f32 v70, v70
    v_exp_f32 v71, v71
    s_waitcnt lgkmcnt(0)
    s_nop 0
    v_smfmac_f32_32x32x32_bf16 v[24:39], v[72:75], v[64:71], v4
    v_readlane_b32 s62, v124, 1
    s_lshl_b32 s63, s7, 3
    s_cmp_ge_u32 s62, s63
    s_cbranch_scc1 FA_XFREE
    s_mov_b32 s75, 0x40000
FA_SP24:
    ds_read_b32 v124, v117 offset:0
    s_waitcnt lgkmcnt(0)
    v_cmp_le_u32 vcc, 8, v124
    s_sub_u32 s75, s75, 1
    s_cbranch_scc1 FA_SX24
    s_and_b32 s70, vcc_lo, 0x2
    s_cmp_eq_u32 s70, 0x2
    s_cbranch_scc0 FA_SP24
FA_SX24:
FA_XFREE:
    s_nop 5
    s_cmp_eq_u32 s58, 0
    s_cbranch_scc0 FA_XW1
    ds_write_b128 v104, v[32:35]
    ds_write_b128 v104, v[36:39] offset:1024
    s_branch FA_XWD
FA_XW1:
    ds_write_b128 v104, v[24:27]
    ds_write_b128 v104, v[28:31] offset:1024
FA_XWD:
    s_mov_b64 exec, 1
    ds_write_b32 v106, v119
    s_mov_b64 exec, -1
    s_mov_b32 s75, 0x40000
FA_SP25:
    ds_read_b32 v124, v107 offset:0
    s_waitcnt lgkmcnt(0)
    v_cmp_le_u32 vcc, 1, v124
    s_sub_u32 s75, s75, 1
    s_cbranch_scc1 FA_SX25
    s_cmp_eq_u64 vcc, -1
    s_cbranch_scc0 FA_SP25
FA_SX25:
    ds_read_b128 v[88:91], v105
    ds_read_b128 v[92:95], v105 offset:1024
    s_cmp_eq_u32 s58, 0
    s_cbranch_scc0 FA_FIN1
    s_waitcnt vmcnt(0) lgkmcnt(0)
    v_pk_add_f32 v[64:65], v[24:25], v[88:89]
    v_pk_add_f32 v[66:67], v[26:27], v[90:91]
    v_pk_add_f32 v[68:69], v[28:29], v[92:93]
    v_pk_add_f32 v[70:71], v[30:31], v[94:95]
    s_branch FA_FIND
FA_FIN1:
    s_waitcnt vmcnt(0) lgkmcnt(0)
    v_pk_add_f32 v[64:65], v[32:33], v[88:89]
    v_pk_add_f32 v[66:67], v[34:35], v[90:91]
    v_pk_add_f32 v[68:69], v[36:37], v[92:93]
    v_pk_add_f32 v[70:71], v[38:39], v[94:95]
FA_FIND:
    v_rcp_f32 v56, v71
    v_pk_add_f32 v[58:59], v[64:65], v[66:67]
    v_cmp_le_f32 s[68:69], s64, v71
    v_pk_add_f32 v[58:59], v[58:59], v[68:69]
    v_mul_f32 v56, v56, v5
    v_pk_add_f32 v[58:59], v[58:59], v[70:71]
    v_cmp_ge_f32 s[70:71], s65, v71
    v_add_f32 v58, v58, v59
    v_pk_mul_f32 v[64:65], v[64:65], v[56:57] op_sel_hi:[1,0]
    v_pk_mul_f32 v[66:67], v[66:67], v[56:57] op_sel_hi:[1,0]
    v_pk_mul_f32 v[68:69], v[68:69], v[56:57] op_sel_hi:[1,0]
    v_cmp_class_f32 vcc, v58, s66
    v_mul_f32 v70, v56, v70
    s_and_b64 s[68:69], s[68:69], s[70:71]
    v_cvt_pk_bf16_f32 v80, v64, v65
    v_cvt_pk_bf16_f32 v81, v66, v67
    v_cvt_pk_bf16_f32 v82, v68, v69
    v_cvt_pk_bf16_f32 v83, v70, v70
    s_and_b64 s[68:69], s[68:69], vcc
    s_cmp_lg_u32 s59, 0
    s_cselect_b64 s[68:69], -1, s[68:69]
    v_bfi_b32 v83, s67, v83, v126
    s_cmp_eq_u64 s[68:69], -1
    s_cbranch_scc1 FA_VALID
    s_mov_b64 exec, 128
    ds_write_b32 v117, v119
    s_mov_b64 exec, -1
    s_branch FA_STORED
FA_VALID:
    s_cmp_lg_u32 s8, 0
    s_cbranch_scc1 FA_STORED
    v_cmp_eq_u32 s[64:65], s56, v112
    v_cmp_eq_u32 vcc, s20, v113
    s_and_b64 vcc, vcc, s[64:65]
    s_cmp_eq_u64 vcc, -1
    s_cbranch_scc0 FA_STX
    buffer_store_dwordx4 v[80:83], v123, s[44:47], s74 offen
    s_branch FA_STD
FA_STX:
    buffer_store_dwordx4 v[80:83], v123, s[44:47], s74 offen sc1
FA_STD:
    s_mov_b32 s8, 1
FA_STORED:
    s_mov_b64 exec, 2
    ds_add_u32 v117, v119
    s_mov_b64 exec, -1
    s_cmp_eq_u32 s7, 0
    s_cbranch_scc1 FA_G0
    s_mov_b32 s75, 0x40000
FA_SP26:
    ds_read_b32 v124, v117 offset:0
    s_waitcnt lgkmcnt(0)
    v_cmp_le_u32 vcc, 16, v124
    s_sub_u32 s75, s75, 1
    s_cbranch_scc1 FA_SX26
    s_and_b32 s70, vcc_lo, 0x2
    s_cmp_eq_u32 s70, 0x2
    s_cbranch_scc0 FA_SP26
FA_SX26:
    v_readlane_b32 s60, v124, 7
    s_cmp_lg_u32 s60, 0
    s_cbranch_scc1 FA_FALLBACK
    s_branch FA_EXIT
FA_G0:
    s_setprio 0
    s_cmp_eq_u32 s6, 7
    s_cbranch_scc0 FA_G0_WORK
FA_G0_VERD:
    s_mov_b32 s75, 0x40000
FA_SP27:
    ds_read_b32 v124, v117 offset:0
    s_waitcnt lgkmcnt(0)
    v_cmp_le_u32 vcc, 16, v124
    s_sub_u32 s75, s75, 1
    s_cbranch_scc1 FA_SX27
    s_and_b32 s70, vcc_lo, 0x2
    s_cmp_eq_u32 s70, 0x2
    s_cbranch_scc0 FA_SP27
FA_SX27:
    v_readlane_b32 s60, v124, 7
    s_cmp_lg_u32 s60, 0
    s_cbranch_scc1 FA_FALLBACK
    s_branch FA_EXIT
FA_G0_WORK:
    s_mov_b32 s40, s12
    s_mov_b32 s41, s13
    v_mov_b32 v104, v120
    v_mov_b32 v108, v121
    v_xor_b32 v105, 32, v120
    v_xor_b32 v109, 32, v121
    v_xor_b32 v106, 64, v120
    v_xor_b32 v110, 64, v121
    v_xor_b32 v107, 96, v120
    v_xor_b32 v111, 96, v121
    ds_read_b64_tr_b16 v[56:57], v104 offset:0
    ds_read_b64_tr_b16 v[58:59], v108 offset:0
    ds_read_b64_tr_b16 v[60:61], v105 offset:0
    ds_read_b64_tr_b16 v[62:63], v109 offset:0
    ds_read_b64_tr_b16 v[64:65], v106 offset:0
    ds_read_b64_tr_b16 v[66:67], v110 offset:0
    ds_read_b64_tr_b16 v[68:69], v107 offset:0
    ds_read_b64_tr_b16 v[70:71], v111 offset:0
    ds_read_b64_tr_b16 v[72:73], v106 offset:3584
    ds_read_b64_tr_b16 v[74:75], v110 offset:3584
    ds_read_b64_tr_b16 v[76:77], v107 offset:3584
    ds_read_b64_tr_b16 v[78:79], v111 offset:3584
    s_waitcnt vmcnt(0) lgkmcnt(0)
    s_add_u32 s60, s10, 0x0
    buffer_load_dwordx4 v[24:27], v1, s[44:47], s60 offen sc1
    s_add_u32 s60, s10, 0x0
    buffer_load_dwordx4 v[28:31], v1, s[44:47], s60 offen offset:1024 sc1
    s_add_u32 s60, s10, 0x1000
    buffer_load_dwordx4 v[32:35], v1, s[44:47], s60 offen sc1
    s_mov_b32 s52, 40000
    s_waitcnt vmcnt(2)
    s_add_u32 s60, s10, 0x1000
    buffer_load_dwordx4 v[36:39], v1, s[44:47], s60 offen offset:1024 sc1
    v_xor_b32 v27, v126, v27
    v_cmp_le_u32 vcc, 0x10000, v27
    ds_read_b64_tr_b16 v[80:81], v104 offset:3584
    ds_read_b64_tr_b16 v[82:83], v108 offset:3584
    s_cbranch_vccnz FA_BR0_0
FA_BO0_0:
    v_mfma_f32_16x16x32_bf16 v[88:91], v[56:59], v[24:27], 0
    ds_read_b64_tr_b16 v[84:85], v105 offset:3584
    ds_read_b64_tr_b16 v[86:87], v109 offset:3584
    v_mfma_f32_16x16x32_bf16 v[92:95], v[60:63], v[24:27], 0
    ds_read_b64_tr_b16 v[8:9], v104 offset:7168
    ds_read_b64_tr_b16 v[10:11], v108 offset:7168
    v_mfma_f32_16x16x32_bf16 v[96:99], v[64:67], v[24:27], 0
    ds_read_b64_tr_b16 v[12:13], v105 offset:7168
    ds_read_b64_tr_b16 v[14:15], v109 offset:7168
    v_mfma_f32_16x16x32_bf16 v[100:103], v[68:71], v[24:27], 0
    s_waitcnt vmcnt(2)
    s_add_u32 s60, s10, 0x2000
    buffer_load_dwordx4 v[40:43], v1, s[44:47], s60 offen sc1
    v_xor_b32 v31, v126, v31
    v_cmp_le_u32 vcc, 0x10000, v31
    ds_read_b64_tr_b16 v[56:57], v106 offset:7168
    ds_read_b64_tr_b16 v[58:59], v110 offset:7168
    s_cbranch_vccnz FA_BR0_1
FA_BO0_1:
    v_mfma_f32_16x16x32_bf16 v[88:91], v[72:75], v[28:31], v[88:91]
    ds_read_b64_tr_b16 v[60:61], v107 offset:7168
    ds_read_b64_tr_b16 v[62:63], v111 offset:7168
    v_mfma_f32_16x16x32_bf16 v[92:95], v[76:79], v[28:31], v[92:95]
    ds_read_b64_tr_b16 v[64:65], v106 offset:10752
    ds_read_b64_tr_b16 v[66:67], v110 offset:10752
    s_waitcnt lgkmcnt(12)
    v_mfma_f32_16x16x32_bf16 v[96:99], v[80:83], v[28:31], v[96:99]
    ds_read_b64_tr_b16 v[68:69], v107 offset:10752
    ds_read_b64_tr_b16 v[70:71], v111 offset:10752
    s_waitcnt lgkmcnt(12)
    v_mfma_f32_16x16x32_bf16 v[100:103], v[84:87], v[28:31], v[100:103]
    s_waitcnt vmcnt(2)
    s_add_u32 s60, s10, 0x2000
    buffer_load_dwordx4 v[44:47], v1, s[44:47], s60 offen offset:1024 sc1
    ds_read_b32 v124, v117
    v_xor_b32 v35, v126, v35
    v_cmp_le_u32 vcc, 0x10000, v35
    ds_read_b64_tr_b16 v[72:73], v104 offset:10752
    ds_read_b64_tr_b16 v[74:75], v108 offset:10752
    s_cbranch_vccnz FA_BR0_2
FA_BO0_2:
    s_waitcnt lgkmcnt(12)
    v_mfma_f32_16x16x32_bf16 v[88:91], v[8:11], v[32:35], v[88:91]
    ds_read_b64_tr_b16 v[76:77], v105 offset:10752
    ds_read_b64_tr_b16 v[78:79], v109 offset:10752
    s_waitcnt lgkmcnt(12)
    v_mfma_f32_16x16x32_bf16 v[92:95], v[12:15], v[32:35], v[92:95]
    ds_read_b64_tr_b16 v[80:81], v104 offset:14336
    ds_read_b64_tr_b16 v[82:83], v108 offset:14336
    s_waitcnt lgkmcnt(12)
    v_mfma_f32_16x16x32_bf16 v[96:99], v[56:59], v[32:35], v[96:99]
    ds_read_b64_tr_b16 v[84:85], v105 offset:14336
    ds_read_b64_tr_b16 v[86:87], v109 offset:14336
    s_waitcnt lgkmcnt(12)
    v_mfma_f32_16x16x32_bf16 v[100:103], v[60:63], v[32:35], v[100:103]
    s_waitcnt vmcnt(2)
    s_add_u32 s60, s10, 0x3000
    buffer_load_dwordx4 v[48:51], v1, s[44:47], s60 offen sc1
    v_xor_b32 v39, v126, v39
    v_cmp_le_u32 vcc, 0x10000, v39
    ds_read_b64_tr_b16 v[8:9], v106 offset:14336
    ds_read_b64_tr_b16 v[10:11], v110 offset:14336
    s_cbranch_vccnz FA_BR0_3
FA_BO0_3:
    s_waitcnt lgkmcnt(12)
    v_mfma_f32_16x16x32_bf16 v[88:91], v[64:67], v[36:39], v[88:91]
    ds_read_b64_tr_b16 v[12:13], v107 offset:14336
    ds_read_b64_tr_b16 v[14:15], v111 offset:14336
    s_waitcnt lgkmcnt(12)
    v_mfma_f32_16x16x32_bf16 v[92:95], v[68:71], v[36:39], v[92:95]
    ds_read_b64_tr_b16 v[56:57], v106 offset:17920
    ds_read_b64_tr_b16 v[58:59], v110 offset:17920
    s_waitcnt lgkmcnt(12)
    v_mfma_f32_16x16x32_bf16 v[96:99], v[72:75], v[36:39], v[96:99]
    ds_read_b64_tr_b16 v[60:61], v107 offset:17920
    ds_read_b64_tr_b16 v[62:63], v111 offset:17920
    s_waitcnt lgkmcnt(12)
    v_mfma_f32_16x16x32_bf16 v[100:103], v[76:79], v[36:39], v[100:103]
    s_waitcnt vmcnt(2)
    s_add_u32 s60, s10, 0x3000
    buffer_load_dwordx4 v[52:55], v1, s[44:47], s60 offen offset:1024 sc1
    s_waitcnt lgkmcnt(12)
    v_readlane_b32 s62, v124, 0
    s_cmp_ge_u32 s62, 16
    s_cbranch_scc1 FA_W28
    s_mov_b32 s75, 0x40000
FA_SP28:
    ds_read_b32 v124, v117 offset:0
    s_waitcnt lgkmcnt(0)
    v_cmp_le_u32 vcc, 16, v124
    s_sub_u32 s75, s75, 1
    s_cbranch_scc1 FA_SX28
    s_and_b32 s70, vcc_lo, 0x1
    s_cmp_eq_u32 s70, 0x1
    s_cbranch_scc0 FA_SP28
FA_SX28:
FA_W28:
    s_min_u32 s62, s3, 6
    s_lshl_b32 s61, s62, 10
    s_mul_i32 s62, s62, 7168
    s_add_u32 m0, s61, 0
    s_add_u32 s63, s62, 50176
    buffer_load_dwordx4 v118, s[40:43], s63 offen lds
    s_add_u32 m0, s61, 7168
    s_add_u32 s63, s62, 150528
    buffer_load_dwordx4 v118, s[40:43], s63 offen lds
    s_add_u32 m0, s61, 14336
    s_add_u32 s63, s62, 250880
    buffer_load_dwordx4 v118, s[40:43], s63 offen lds
    s_add_u32 m0, s61, 21504
    s_add_u32 s63, s62, 351232
    buffer_load_dwordx4 v118, s[40:43], s63 offen lds
    v_xor_b32 v43, v126, v43
    v_cmp_le_u32 vcc, 0x10000, v43
    ds_read_b64_tr_b16 v[64:65], v104 offset:17920
    ds_read_b64_tr_b16 v[66:67], v108 offset:17920
    s_cbranch_vccnz FA_BR0_4
FA_BO0_4:
    s_waitcnt lgkmcnt(12)
    v_mfma_f32_16x16x32_bf16 v[88:91], v[80:83], v[40:43], v[88:91]
    ds_read_b64_tr_b16 v[68:69], v105 offset:17920
    ds_read_b64_tr_b16 v[70:71], v109 offset:17920
    s_waitcnt lgkmcnt(12)
    v_mfma_f32_16x16x32_bf16 v[92:95], v[84:87], v[40:43], v[92:95]
    ds_read_b64_tr_b16 v[72:73], v104 offset:21504
    ds_read_b64_tr_b16 v[74:75], v108 offset:21504
    s_waitcnt lgkmcnt(12)
    v_mfma_f32_16x16x32_bf16 v[96:99], v[8:11], v[40:43], v[96:99]
    ds_read_b64_tr_b16 v[76:77], v105 offset:21504
    ds_read_b64_tr_b16 v[78:79], v109 offset:21504
    s_waitcnt lgkmcnt(12)
    v_mfma_f32_16x16x32_bf16 v[100:103], v[12:15], v[40:43], v[100:103]
    s_waitcnt vmcnt(6)
    v_xor_b32 v47, v126, v47
    v_cmp_le_u32 vcc, 0x10000, v47
    ds_read_b64_tr_b16 v[80:81], v106 offset:21504
    ds_read_b64_tr_b16 v[82:83], v110 offset:21504
    s_cbranch_vccnz FA_BR0_5
FA_BO0_5:
    s_waitcnt lgkmcnt(12)
    v_mfma_f32_16x16x32_bf16 v[88:91], v[56:59], v[44:47], v[88:91]
    ds_read_b64_tr_b16 v[84:85], v107 offset:21504
    ds_read_b64_tr_b16 v[86:87], v111 offset:21504
    s_waitcnt lgkmcnt(12)
    v_mfma_f32_16x16x32_bf16 v[92:95], v[60:63], v[44:47], v[92:95]
    ds_read_b64_tr_b16 v[8:9], v106 offset:25088
    ds_read_b64_tr_b16 v[10:11], v110 offset:25088
    s_waitcnt lgkmcnt(12)
    v_mfma_f32_16x16x32_bf16 v[96:99], v[64:67], v[44:47], v[96:99]
    ds_read_b64_tr_b16 v[12:13], v107 offset:25088
    ds_read_b64_tr_b16 v[14:15], v111 offset:25088
    s_waitcnt lgkmcnt(12)
    v_mfma_f32_16x16x32_bf16 v[100:103], v[68:71], v[44:47], v[100:103]
    s_waitcnt vmcnt(5)
    v_xor_b32 v51, v126, v51
    v_cmp_le_u32 vcc, 0x10000, v51
    ds_read_b64_tr_b16 v[56:57], v104 offset:25088
    ds_read_b64_tr_b16 v[58:59], v108 offset:25088
    s_cbranch_vccnz FA_BR0_6
FA_BO0_6:
    s_waitcnt lgkmcnt(12)
    v_mfma_f32_16x16x32_bf16 v[88:91], v[72:75], v[48:51], v[88:91]
    ds_read_b64_tr_b16 v[60:61], v105 offset:25088
    ds_read_b64_tr_b16 v[62:63], v109 offset:25088
    s_waitcnt lgkmcnt(12)
    v_mfma_f32_16x16x32_bf16 v[92:95], v[76:79], v[48:51], v[92:95]
    s_waitcnt lgkmcnt(10)
    v_mfma_f32_16x16x32_bf16 v[96:99], v[80:83], v[48:51], v[96:99]
    s_waitcnt lgkmcnt(8)
    v_mfma_f32_16x16x32_bf16 v[100:103], v[84:87], v[48:51], v[100:103]
    s_waitcnt vmcnt(4)
    v_xor_b32 v55, v126, v55
    v_cmp_le_u32 vcc, 0x10000, v55
    s_cbranch_vccnz FA_BR0_7
FA_BO0_7:
    s_waitcnt lgkmcnt(6)
    v_mfma_f32_16x16x32_bf16 v[88:91], v[8:11], v[52:55], v[88:91]
    s_waitcnt lgkmcnt(4)
    v_mfma_f32_16x16x32_bf16 v[92:95], v[12:15], v[52:55], v[92:95]
    s_waitcnt lgkmcnt(2)
    v_mfma_f32_16x16x32_bf16 v[96:99], v[56:59], v[52:55], v[96:99]
    s_waitcnt lgkmcnt(0)
    v_mfma_f32_16x16x32_bf16 v[100:103], v[60:63], v[52:55], v[100:103]
    v_add_u32 v104, s15, v104
    v_add_u32 v105, s15, v105
    v_add_u32 v106, s15, v106
    v_add_u32 v107, s15, v107
    v_add_u32 v108, s15, v108
    v_add_u32 v109, s15, v109
    v_add_u32 v110, s15, v110
    v_add_u32 v111, s15, v111
    s_waitcnt vmcnt(0)
    s_mov_b64 exec, 32
    ds_add_u32 v117, v119
    s_mov_b64 exec, -1
    s_mov_b32 s75, 0x40000
FA_SP29:
    ds_read_b32 v124, v117 offset:0
    s_waitcnt lgkmcnt(0)
    v_cmp_le_u32 vcc, 16, v124
    s_sub_u32 s75, s75, 1
    s_cbranch_scc1 FA_SX29
    s_and_b32 s70, vcc_lo, 0x2
    s_cmp_eq_u32 s70, 0x2
    s_cbranch_scc0 FA_SP29
FA_SX29:
    v_readlane_b32 s60, v124, 7
    s_cmp_lg_u32 s60, 0
    s_cbranch_scc1 FA_FALLBACK
    s_setprio 3
    s_cmp_eq_u32 s58, 0
    s_cbranch_scc0 FA_GB1
    s_setprio 2
FA_GB1:
    s_mov_b32 s40, s22
    s_mov_b32 s41, s23
    s_cmp_lt_u32 s3, 7
    s_cbranch_scc0 FA_WLB
    s_add_u32 m0, s18, 32768
    s_add_u32 s63, s19, 301056
    buffer_load_dwordx4 v118, s[40:43], s63 offen lds
FA_WLB:
    s_add_u32 s60, s10, 0x0
    buffer_load_dwordx4 v[24:27], v1, s[44:47], s60 offen offset:2048 sc1
    s_add_u32 s60, s10, 0x0
    buffer_load_dwordx4 v[28:31], v1, s[44:47], s60 offen offset:3072 sc1
    s_add_u32 s60, s10, 0x1000
    buffer_load_dwordx4 v[32:35], v1, s[44:47], s60 offen offset:2048 sc1
    s_lshl_b32 s60, s3, 11
    s_xor_b32 s61, s60, 8192
    s_add_u32 s60, s60, 40960
    s_add_u32 s61, s61, 40960
    v_add_u32 v2, s60, v1
    v_add_u32 v3, s61, v1
    s_lshl_b32 s60, s3, 2
    s_add_u32 s60, s60, 162944
    s_xor_b32 s61, s60, 16
    v_mov_b32 v4, s60
    v_mov_b32 v6, s61
    v_mov_b32 v7, 2
    s_lshl_b32 s62, s32, 6
    s_lshl_b32 s63, s11, 4
    s_add_u32 s62, s62, s63
    v_and_b32 v5, 15, v0
    v_add_u32 v5, s62, v5
    v_mul_u32_u24 v5, 896, v5
    v_bfe_u32 v11, v0, 4, 1
    v_lshl_add_u32 v5, v11, 5, v5
    v_lshrrev_b32 v11, 5, v0
    v_lshl_add_u32 v5, v11, 4, v5
    s_lshl_b32 s62, s6, 7
    s_lshl_b32 s63, s14, 6
    s_add_u32 s4, s62, s63
    s_mov_b32 s75, 0x40000
FA_SP30:
    ds_read_b32 v124, v117 offset:0
    s_waitcnt lgkmcnt(0)
    v_cmp_le_u32 vcc, 8, v124
    s_sub_u32 s75, s75, 1
    s_cbranch_scc1 FA_SX30
    s_and_b32 s70, vcc_lo, 0x20
    s_cmp_eq_u32 s70, 0x20
    s_cbranch_scc0 FA_SP30
FA_SX30:
    ds_read_b64_tr_b16 v[56:57], v104 offset:0
    ds_read_b64_tr_b16 v[58:59], v108 offset:0
    ds_read_b64_tr_b16 v[60:61], v105 offset:0
    ds_read_b64_tr_b16 v[62:63], v109 offset:0
    ds_read_b64_tr_b16 v[64:65], v106 offset:0
    ds_read_b64_tr_b16 v[66:67], v110 offset:0
    ds_read_b64_tr_b16 v[68:69], v107 offset:0
    ds_read_b64_tr_b16 v[70:71], v111 offset:0
    ds_read_b64_tr_b16 v[72:73], v106 offset:3584
    ds_read_b64_tr_b16 v[74:75], v110 offset:3584
    ds_read_b64_tr_b16 v[76:77], v107 offset:3584
    ds_read_b64_tr_b16 v[78:79], v111 offset:3584
    s_mov_b32 s52, 40000
    s_waitcnt vmcnt(2)
    s_add_u32 s60, s10, 0x1000
    buffer_load_dwordx4 v[36:39], v1, s[44:47], s60 offen offset:3072 sc1
    s_mov_b64 exec, 8
    ds_add_u32 v117, v119
    s_mov_b64 exec, -1
    v_xor_b32 v27, v126, v27
    v_cmp_le_u32 vcc, 0x10000, v27
    ds_read_b64_tr_b16 v[80:81], v104 offset:3584
    ds_read_b64_tr_b16 v[82:83], v108 offset:3584
    s_cbranch_vccnz FA_BR1_0
FA_BO1_0:
    s_waitcnt lgkmcnt(12)
    v_mfma_f32_16x16x32_bf16 v[88:91], v[56:59], v[24:27], v[88:91]
    ds_read_b64_tr_b16 v[84:85], v105 offset:3584
    ds_read_b64_tr_b16 v[86:87], v109 offset:3584
    s_waitcnt lgkmcnt(12)
    v_mfma_f32_16x16x32_bf16 v[92:95], v[60:63], v[24:27], v[92:95]
    ds_read_b64_tr_b16 v[8:9], v104 offset:7168
    ds_read_b64_tr_b16 v[10:11], v108 offset:7168
    s_waitcnt lgkmcnt(12)
    v_mfma_f32_16x16x32_bf16 v[96:99], v[64:67], v[24:27], v[96:99]
    ds_read_b64_tr_b16 v[12:13], v105 offset:7168
    ds_read_b64_tr_b16 v[14:15], v109 offset:7168
    s_waitcnt lgkmcnt(12)
    v_mfma_f32_16x16x32_bf16 v[100:103], v[68:71], v[24:27], v[100:103]
    s_waitcnt vmcnt(2)
    s_add_u32 s60, s10, 0x2000
    buffer_load_dwordx4 v[40:43], v1, s[44:47], s60 offen offset:2048 sc1
    v_xor_b32 v31, v126, v31
    v_cmp_le_u32 vcc, 0x10000, v31
    ds_read_b64_tr_b16 v[56:57], v106 offset:7168
    ds_read_b64_tr_b16 v[58:59], v110 offset:7168
    s_cbranch_vccnz FA_BR1_1
FA_BO1_1:
    s_waitcnt lgkmcnt(12)
    v_mfma_f32_16x16x32_bf16 v[88:91], v[72:75], v[28:31], v[88:91]
    ds_read_b64_tr_b16 v[60:61], v107 offset:7168
    ds_read_b64_tr_b16 v[62:63], v111 offset:7168
    s_waitcnt lgkmcnt(12)
    v_mfma_f32_16x16x32_bf16 v[92:95], v[76:79], v[28:31], v[92:95]
    ds_read_b64_tr_b16 v[64:65], v106 offset:10752
    ds_read_b64_tr_b16 v[66:67], v110 offset:10752
    s_waitcnt lgkmcnt(12)
    v_mfma_f32_16x16x32_bf16 v[96:99], v[80:83], v[28:31], v[96:99]
    ds_read_b64_tr_b16 v[68:69], v107 offset:10752
    ds_read_b64_tr_b16 v[70:71], v111 offset:10752
    s_waitcnt lgkmcnt(12)
    v_mfma_f32_16x16x32_bf16 v[100:103], v[84:87], v[28:31], v[100:103]
    s_waitcnt vmcnt(2)
    s_add_u32 s60, s10, 0x2000
    buffer_load_dwordx4 v[44:47], v1, s[44:47], s60 offen offset:3072 sc1
    v_xor_b32 v35, v126, v35
    v_cmp_le_u32 vcc, 0x10000, v35
    ds_read_b64_tr_b16 v[72:73], v104 offset:10752
    ds_read_b64_tr_b16 v[74:75], v108 offset:10752
    s_cbranch_vccnz FA_BR1_2
FA_BO1_2:
    s_waitcnt lgkmcnt(12)
    v_mfma_f32_16x16x32_bf16 v[88:91], v[8:11], v[32:35], v[88:91]
    ds_read_b64_tr_b16 v[76:77], v105 offset:10752
    ds_read_b64_tr_b16 v[78:79], v109 offset:10752
    s_waitcnt lgkmcnt(12)
    v_mfma_f32_16x16x32_bf16 v[92:95], v[12:15], v[32:35], v[92:95]
    v_add_u32 v104, s16, v104
    v_add_u32 v105, s16, v105
    v_add_u32 v106, s16, v106
    v_add_u32 v107, s16, v107
    v_add_u32 v108, s16, v108
    v_add_u32 v109, s16, v109
    v_add_u32 v110, s16, v110
    v_add_u32 v111, s16, v111
    ds_read_b64_tr_b16 v[80:81], v104 offset:14336
    ds_read_b64_tr_b16 v[82:83], v108 offset:14336
    s_waitcnt lgkmcnt(12)
    v_mfma_f32_16x16x32_bf16 v[96:99], v[56:59], v[32:35], v[96:99]
    ds_read_b64_tr_b16 v[84:85], v105 offset:14336
    ds_read_b64_tr_b16 v[86:87], v109 offset:14336
    s_waitcnt lgkmcnt(12)
    v_mfma_f32_16x16x32_bf16 v[100:103], v[60:63], v[32:35], v[100:103]
    s_waitcnt vmcnt(2)
    s_add_u32 s60, s10, 0x3000
    buffer_load_dwordx4 v[48:51], v1, s[44:47], s60 offen offset:2048 sc1
    v_xor_b32 v39, v126, v39
    v_cmp_le_u32 vcc, 0x10000, v39
    ds_read_b64_tr_b16 v[8:9], v106 offset:14336
    ds_read_b64_tr_b16 v[10:11], v110 offset:14336
    s_cbranch_vccnz FA_BR1_3
FA_BO1_3:
    s_waitcnt lgkmcnt(12)
    v_mfma_f32_16x16x32_bf16 v[88:91], v[64:67], v[36:39], v[88:91]
    ds_read_b64_tr_b16 v[12:13], v107 offset:14336
    ds_read_b64_tr_b16 v[14:15], v111 offset:14336
    s_waitcnt lgkmcnt(12)
    v_mfma_f32_16x16x32_bf16 v[92:95], v[68:71], v[36:39], v[92:95]
    ds_read_b64_tr_b16 v[56:57], v106 offset:17920
    ds_read_b64_tr_b16 v[58:59], v110 offset:17920
    s_waitcnt lgkmcnt(12)
    v_mfma_f32_16x16x32_bf16 v[96:99], v[72:75], v[36:39], v[96:99]
    ds_read_b64_tr_b16 v[60:61], v107 offset:17920
    ds_read_b64_tr_b16 v[62:63], v111 offset:17920
    s_waitcnt lgkmcnt(12)
    v_mfma_f32_16x16x32_bf16 v[100:103], v[76:79], v[36:39], v[100:103]
    s_waitcnt vmcnt(2)
    s_add_u32 s60, s10, 0x3000
    buffer_load_dwordx4 v[52:55], v1, s[44:47], s60 offen offset:3072 sc1
    s_mov_b32 s75, 0x40000
FA_SP31:
    ds_read_b32 v124, v117 offset:0
    s_waitcnt lgkmcnt(0)
    v_cmp_le_u32 vcc, 8, v124
    s_sub_u32 s75, s75, 1
    s_cbranch_scc1 FA_SX31
    s_and_b32 s70, vcc_lo, 0x8
    s_cmp_eq_u32 s70, 0x8
    s_cbranch_scc0 FA_SP31
FA_SX31:
    v_xor_b32 v43, v126, v43
    v_cmp_le_u32 vcc, 0x10000, v43
    ds_read_b64_tr_b16 v[64:65], v104 offset:17920
    ds_read_b64_tr_b16 v[66:67], v108 offset:17920
    s_cbranch_vccnz FA_BR1_4
FA_BO1_4:
    s_waitcnt lgkmcnt(12)
    v_mfma_f32_16x16x32_bf16 v[88:91], v[80:83], v[40:43], v[88:91]
    ds_read_b64_tr_b16 v[68:69], v105 offset:17920
    ds_read_b64_tr_b16 v[70:71], v109 offset:17920
    s_waitcnt lgkmcnt(12)
    v_mfma_f32_16x16x32_bf16 v[92:95], v[84:87], v[40:43], v[92:95]
    v_add_u32 v104, s17, v104
    v_add_u32 v105, s17, v105
    v_add_u32 v106, s17, v106
    v_add_u32 v107, s17, v107
    v_add_u32 v108, s17, v108
    v_add_u32 v109, s17, v109
    v_add_u32 v110, s17, v110
    v_add_u32 v111, s17, v111
    ds_read_b64_tr_b16 v[72:73], v104 offset:21504
    ds_read_b64_tr_b16 v[74:75], v108 offset:21504
    s_waitcnt lgkmcnt(12)
    v_mfma_f32_16x16x32_bf16 v[96:99], v[8:11], v[40:43], v[96:99]
    ds_read_b64_tr_b16 v[76:77], v105 offset:21504
    ds_read_b64_tr_b16 v[78:79], v109 offset:21504
    s_waitcnt lgkmcnt(12)
    v_mfma_f32_16x16x32_bf16 v[100:103], v[12:15], v[40:43], v[100:103]
    s_waitcnt vmcnt(2)
    v_xor_b32 v47, v126, v47
    v_cmp_le_u32 vcc, 0x10000, v47
    ds_read_b64_tr_b16 v[80:81], v106 offset:21504
    ds_read_b64_tr_b16 v[82:83], v110 offset:21504
    s_cbranch_vccnz FA_BR1_5
FA_BO1_5:
    s_waitcnt lgkmcnt(12)
    v_mfma_f32_16x16x32_bf16 v[88:91], v[56:59], v[44:47], v[88:91]
    ds_read_b64_tr_b16 v[84:85], v107 offset:21504
    ds_read_b64_tr_b16 v[86:87], v111 offset:21504
    s_waitcnt lgkmcnt(12)
    v_mfma_f32_16x16x32_bf16 v[92:95], v[60:63], v[44:47], v[92:95]
    ds_read_b64_tr_b16 v[8:9], v104 offset:25088
    ds_read_b64_tr_b16 v[10:11], v108 offset:25088
    s_waitcnt lgkmcnt(12)
    v_mfma_f32_16x16x32_bf16 v[96:99], v[64:67], v[44:47], v[96:99]
    ds_read_b64_tr_b16 v[12:13], v105 offset:25088
    ds_read_b64_tr_b16 v[14:15], v109 offset:25088
    s_waitcnt lgkmcnt(12)
    v_mfma_f32_16x16x32_bf16 v[100:103], v[68:71], v[44:47], v[100:103]
    s_waitcnt vmcnt(1)
    v_xor_b32 v51, v126, v51
    v_cmp_le_u32 vcc, 0x10000, v51
    ds_read_b64_tr_b16 v[56:57], v106 offset:25088
    ds_read_b64_tr_b16 v[58:59], v110 offset:25088
    s_cbranch_vccnz FA_BR1_6
FA_BO1_6:
    s_waitcnt lgkmcnt(12)
    v_mfma_f32_16x16x32_bf16 v[88:91], v[72:75], v[48:51], v[88:91]
    ds_read_b64_tr_b16 v[60:61], v107 offset:25088
    ds_read_b64_tr_b16 v[62:63], v111 offset:25088
    s_waitcnt lgkmcnt(12)
    v_mfma_f32_16x16x32_bf16 v[92:95], v[76:79], v[48:51], v[92:95]
    s_waitcnt lgkmcnt(10)
    v_mfma_f32_16x16x32_bf16 v[96:99], v[80:83], v[48:51], v[96:99]
    s_waitcnt lgkmcnt(8)
    v_mfma_f32_16x16x32_bf16 v[100:103], v[84:87], v[48:51], v[100:103]
    s_waitcnt vmcnt(0)
    v_xor_b32 v55, v126, v55
    v_cmp_le_u32 vcc, 0x10000, v55
    s_cbranch_vccnz FA_BR1_7
FA_BO1_7:
    s_waitcnt lgkmcnt(6)
    v_mfma_f32_16x16x32_bf16 v[96:99], v[8:11], v[52:55], v[96:99]
    s_waitcnt lgkmcnt(4)
    v_mfma_f32_16x16x32_bf16 v[100:103], v[12:15], v[52:55], v[100:103]
    s_waitcnt lgkmcnt(2)
    v_mfma_f32_16x16x32_bf16 v[88:91], v[56:59], v[52:55], v[88:91]
    s_waitcnt lgkmcnt(0)
    v_mfma_f32_16x16x32_bf16 v[92:95], v[60:63], v[52:55], v[92:95]
    s_nop 2
    ds_write_b128 v2, v[96:99]
    ds_write_b128 v2, v[100:103] offset:1024
    s_mov_b64 exec, 1
    ds_write_b32 v4, v7
    s_mov_b64 exec, -1
    s_mov_b32 s75, 0x40000
FA_SP32:
    ds_read_b32 v124, v6 offset:0
    s_waitcnt lgkmcnt(0)
    v_cmp_le_u32 vcc, 2, v124
    s_sub_u32 s75, s75, 1
    s_cbranch_scc1 FA_SX32
    s_cmp_eq_u64 vcc, -1
    s_cbranch_scc0 FA_SP32
FA_SX32:
    ds_read_b128 v[56:59], v3
    ds_read_b128 v[60:63], v3 offset:1024
    s_waitcnt lgkmcnt(0)
    v_add_f32 v88, v88, v56
    v_add_f32 v89, v89, v57
    v_add_f32 v90, v90, v58
    v_add_f32 v91, v91, v59
    v_add_f32 v92, v92, v60
    v_add_f32 v93, v93, v61
    v_add_f32 v94, v94, v62
    v_add_f32 v95, v95, v63
    v_cvt_pk_bf16_f32 v72, v88, v89
    v_cvt_pk_bf16_f32 v73, v90, v91
    v_cvt_pk_bf16_f32 v74, v92, v93
    v_cvt_pk_bf16_f32 v75, v94, v95
    s_nop 1
    v_permlane16_swap_b32 v72, v74
    v_permlane16_swap_b32 v73, v75
    s_nop 1
    buffer_store_dwordx4 v[72:75], v5, s[36:39], s4 offen
FA_EXIT:
    s_endpgm
FA_BR0_0:
    s_cmp_eq_u32 s52, 0
    s_cbranch_scc1 FA_BO0_0
    s_sub_u32 s52, s52, 1
    s_add_u32 s60, s10, 0x0
    buffer_load_dwordx4 v[24:27], v1, s[44:47], s60 offen sc1
    ds_read_b32 v124, v117
    s_waitcnt lgkmcnt(0)
    v_readlane_b32 s60, v124, 7
    s_cmp_lg_u32 s60, 0
    s_cbranch_scc1 FA_G0_VERD
    s_waitcnt vmcnt(0)
    v_xor_b32 v27, v126, v27
    v_cmp_le_u32 vcc, 0x10000, v27
    s_cbranch_vccnz FA_BR0_0
    s_branch FA_BO0_0
FA_BR0_1:
    s_cmp_eq_u32 s52, 0
    s_cbranch_scc1 FA_BO0_1
    s_sub_u32 s52, s52, 1
    s_add_u32 s60, s10, 0x0
    buffer_load_dwordx4 v[28:31], v1, s[44:47], s60 offen offset:1024 sc1
    ds_read_b32 v124, v117
    s_waitcnt lgkmcnt(0)
    v_readlane_b32 s60, v124, 7
    s_cmp_lg_u32 s60, 0
    s_cbranch_scc1 FA_G0_VERD
    s_waitcnt vmcnt(0)
    v_xor_b32 v31, v126, v31
    v_cmp_le_u32 vcc, 0x10000, v31
    s_cbranch_vccnz FA_BR0_1
    s_branch FA_BO0_1
FA_BR0_2:
    s_cmp_eq_u32 s52, 0
    s_cbranch_scc1 FA_BO0_2
    s_sub_u32 s52, s52, 1
    s_add_u32 s60, s10, 0x1000
    buffer_load_dwordx4 v[32:35], v1, s[44:47], s60 offen sc1
    ds_read_b32 v124, v117
    s_waitcnt lgkmcnt(0)
    v_readlane_b32 s60, v124, 7
    s_cmp_lg_u32 s60, 0
    s_cbranch_scc1 FA_G0_VERD
    s_waitcnt vmcnt(0)
    v_xor_b32 v35, v126, v35
    v_cmp_le_u32 vcc, 0x10000, v35
    s_cbranch_vccnz FA_BR0_2
    s_branch FA_BO0_2
FA_BR0_3:
    s_cmp_eq_u32 s52, 0
    s_cbranch_scc1 FA_BO0_3
    s_sub_u32 s52, s52, 1
    s_add_u32 s60, s10, 0x1000
    buffer_load_dwordx4 v[36:39], v1, s[44:47], s60 offen offset:1024 sc1
    ds_read_b32 v124, v117
    s_waitcnt lgkmcnt(0)
    v_readlane_b32 s60, v124, 7
    s_cmp_lg_u32 s60, 0
    s_cbranch_scc1 FA_G0_VERD
    s_waitcnt vmcnt(0)
    v_xor_b32 v39, v126, v39
    v_cmp_le_u32 vcc, 0x10000, v39
    s_cbranch_vccnz FA_BR0_3
    s_branch FA_BO0_3
FA_BR0_4:
    s_cmp_eq_u32 s52, 0
    s_cbranch_scc1 FA_BO0_4
    s_sub_u32 s52, s52, 1
    s_add_u32 s60, s10, 0x2000
    buffer_load_dwordx4 v[40:43], v1, s[44:47], s60 offen sc1
    ds_read_b32 v124, v117
    s_waitcnt lgkmcnt(0)
    v_readlane_b32 s60, v124, 7
    s_cmp_lg_u32 s60, 0
    s_cbranch_scc1 FA_G0_VERD
    s_waitcnt vmcnt(0)
    v_xor_b32 v43, v126, v43
    v_cmp_le_u32 vcc, 0x10000, v43
    s_cbranch_vccnz FA_BR0_4
    s_branch FA_BO0_4
FA_BR0_5:
    s_cmp_eq_u32 s52, 0
    s_cbranch_scc1 FA_BO0_5
    s_sub_u32 s52, s52, 1
    s_add_u32 s60, s10, 0x2000
    buffer_load_dwordx4 v[44:47], v1, s[44:47], s60 offen offset:1024 sc1
    ds_read_b32 v124, v117
    s_waitcnt lgkmcnt(0)
    v_readlane_b32 s60, v124, 7
    s_cmp_lg_u32 s60, 0
    s_cbranch_scc1 FA_G0_VERD
    s_waitcnt vmcnt(0)
    v_xor_b32 v47, v126, v47
    v_cmp_le_u32 vcc, 0x10000, v47
    s_cbranch_vccnz FA_BR0_5
    s_branch FA_BO0_5
FA_BR0_6:
    s_cmp_eq_u32 s52, 0
    s_cbranch_scc1 FA_BO0_6
    s_sub_u32 s52, s52, 1
    s_add_u32 s60, s10, 0x3000
    buffer_load_dwordx4 v[48:51], v1, s[44:47], s60 offen sc1
    ds_read_b32 v124, v117
    s_waitcnt lgkmcnt(0)
    v_readlane_b32 s60, v124, 7
    s_cmp_lg_u32 s60, 0
    s_cbranch_scc1 FA_G0_VERD
    s_waitcnt vmcnt(0)
    v_xor_b32 v51, v126, v51
    v_cmp_le_u32 vcc, 0x10000, v51
    s_cbranch_vccnz FA_BR0_6
    s_branch FA_BO0_6
FA_BR0_7:
    s_cmp_eq_u32 s52, 0
    s_cbranch_scc1 FA_BO0_7
    s_sub_u32 s52, s52, 1
    s_add_u32 s60, s10, 0x3000
    buffer_load_dwordx4 v[52:55], v1, s[44:47], s60 offen offset:1024 sc1
    ds_read_b32 v124, v117
    s_waitcnt lgkmcnt(0)
    v_readlane_b32 s60, v124, 7
    s_cmp_lg_u32 s60, 0
    s_cbranch_scc1 FA_G0_VERD
    s_waitcnt vmcnt(0)
    v_xor_b32 v55, v126, v55
    v_cmp_le_u32 vcc, 0x10000, v55
    s_cbranch_vccnz FA_BR0_7
    s_branch FA_BO0_7
FA_BR1_0:
    s_cmp_eq_u32 s52, 0
    s_cbranch_scc1 FA_BO1_0
    s_sub_u32 s52, s52, 1
    s_add_u32 s60, s10, 0x0
    buffer_load_dwordx4 v[24:27], v1, s[44:47], s60 offen offset:2048 sc1
    s_waitcnt vmcnt(0)
    v_xor_b32 v27, v126, v27
    v_cmp_le_u32 vcc, 0x10000, v27
    s_cbranch_vccnz FA_BR1_0
    s_branch FA_BO1_0
FA_BR1_1:
    s_cmp_eq_u32 s52, 0
    s_cbranch_scc1 FA_BO1_1
    s_sub_u32 s52, s52, 1
    s_add_u32 s60, s10, 0x0
    buffer_load_dwordx4 v[28:31], v1, s[44:47], s60 offen offset:3072 sc1
    s_waitcnt vmcnt(0)
    v_xor_b32 v31, v126, v31
    v_cmp_le_u32 vcc, 0x10000, v31
    s_cbranch_vccnz FA_BR1_1
    s_branch FA_BO1_1
FA_BR1_2:
    s_cmp_eq_u32 s52, 0
    s_cbranch_scc1 FA_BO1_2
    s_sub_u32 s52, s52, 1
    s_add_u32 s60, s10, 0x1000
    buffer_load_dwordx4 v[32:35], v1, s[44:47], s60 offen offset:2048 sc1
    s_waitcnt vmcnt(0)
    v_xor_b32 v35, v126, v35
    v_cmp_le_u32 vcc, 0x10000, v35
    s_cbranch_vccnz FA_BR1_2
    s_branch FA_BO1_2
FA_BR1_3:
    s_cmp_eq_u32 s52, 0
    s_cbranch_scc1 FA_BO1_3
    s_sub_u32 s52, s52, 1
    s_add_u32 s60, s10, 0x1000
    buffer_load_dwordx4 v[36:39], v1, s[44:47], s60 offen offset:3072 sc1
    s_waitcnt vmcnt(0)
    v_xor_b32 v39, v126, v39
    v_cmp_le_u32 vcc, 0x10000, v39
    s_cbranch_vccnz FA_BR1_3
    s_branch FA_BO1_3
FA_BR1_4:
    s_cmp_eq_u32 s52, 0
    s_cbranch_scc1 FA_BO1_4
    s_sub_u32 s52, s52, 1
    s_add_u32 s60, s10, 0x2000
    buffer_load_dwordx4 v[40:43], v1, s[44:47], s60 offen offset:2048 sc1
    s_waitcnt vmcnt(0)
    v_xor_b32 v43, v126, v43
    v_cmp_le_u32 vcc, 0x10000, v43
    s_cbranch_vccnz FA_BR1_4
    s_branch FA_BO1_4
FA_BR1_5:
    s_cmp_eq_u32 s52, 0
    s_cbranch_scc1 FA_BO1_5
    s_sub_u32 s52, s52, 1
    s_add_u32 s60, s10, 0x2000
    buffer_load_dwordx4 v[44:47], v1, s[44:47], s60 offen offset:3072 sc1
    s_waitcnt vmcnt(0)
    v_xor_b32 v47, v126, v47
    v_cmp_le_u32 vcc, 0x10000, v47
    s_cbranch_vccnz FA_BR1_5
    s_branch FA_BO1_5
FA_BR1_6:
    s_cmp_eq_u32 s52, 0
    s_cbranch_scc1 FA_BO1_6
    s_sub_u32 s52, s52, 1
    s_add_u32 s60, s10, 0x3000
    buffer_load_dwordx4 v[48:51], v1, s[44:47], s60 offen offset:2048 sc1
    s_waitcnt vmcnt(0)
    v_xor_b32 v51, v126, v51
    v_cmp_le_u32 vcc, 0x10000, v51
    s_cbranch_vccnz FA_BR1_6
    s_branch FA_BO1_6
FA_BR1_7:
    s_cmp_eq_u32 s52, 0
    s_cbranch_scc1 FA_BO1_7
    s_sub_u32 s52, s52, 1
    s_add_u32 s60, s10, 0x3000
    buffer_load_dwordx4 v[52:55], v1, s[44:47], s60 offen offset:3072 sc1
    s_waitcnt vmcnt(0)
    v_xor_b32 v55, v126, v55
    v_cmp_le_u32 vcc, 0x10000, v55
    s_cbranch_vccnz FA_BR1_7
    s_branch FA_BO1_7
FA_FALLBACK:
    v_mov_b32 v10, 0xff800000
    s_mov_b32 s54, 0
    s_waitcnt vmcnt(0) lgkmcnt(0)
    s_barrier
    v_lshlrev_b32 v8, 2, v0
    v_add_u32 v8, 162944, v8
    v_mov_b32 v9, 0
    s_cmp_eq_u32 s3, 0
    s_cbranch_scc0 FA_FB_KEEP
    s_mov_b32 exec_hi, 0
    ds_write_b32 v8, v9
    s_mov_b32 exec_hi, -1
FA_FB_KEEP:
    s_cmp_eq_u32 s7, 0
    s_cselect_b64 s[40:41], s[12:13], s[22:23]
    s_bfe_u32 s62, s3, 0x20001
    s_and_b32 s63, s3, 1
    s_mul_i32 s63, s63, 21504
    s_mul_i32 s4, s62, 100352
    s_add_u32 s4, s4, s63
    s_lshl_b32 s62, s3, 11
    v_add_u32 v6, s62, v1
FA_FB_LOOP:
    s_lshl_b32 s60, s54, 15
    s_add_u32 s60, s60, s72
    buffer_load_dwordx4 v[104:107], v1, s[44:47], s60 offen sc1
    buffer_load_dwordx4 v[108:111], v1, s[44:47], s60 offen offset:1024 sc1
    s_barrier
    s_waitcnt vmcnt(0)
    ds_write_b128 v6, v[104:107] offset:0
    ds_write_b128 v6, v[108:111] offset:1024
    s_waitcnt lgkmcnt(0)
    s_barrier
    ds_read_b128 v[72:75], v2 offset:0
    ds_read_b128 v[76:79], v2 offset:1024
    s_waitcnt lgkmcnt(0)
    v_mfma_f32_32x32x16_bf16 v[40:55], v[72:75], v[16:19], 0
    v_mfma_f32_32x32x16_bf16 v[40:55], v[76:79], v[20:23], v[40:55]
    s_nop 11
    v_max3_f32 v10, v40, v41, v10
    v_max3_f32 v10, v42, v43, v10
    v_max3_f32 v10, v44, v45, v10
    v_max3_f32 v10, v46, v47, v10
    v_max3_f32 v10, v48, v49, v10
    v_max3_f32 v10, v50, v51, v10
    v_max3_f32 v10, v52, v53, v10
    v_max3_f32 v10, v54, v55, v10
    s_nop 7
    ds_read_b128 v[72:75], v2 offset:4096
    ds_read_b128 v[76:79], v2 offset:5120
    s_waitcnt lgkmcnt(0)
    v_mfma_f32_32x32x16_bf16 v[40:55], v[72:75], v[16:19], 0
    v_mfma_f32_32x32x16_bf16 v[40:55], v[76:79], v[20:23], v[40:55]
    s_nop 11
    v_max3_f32 v10, v40, v41, v10
    v_max3_f32 v10, v42, v43, v10
    v_max3_f32 v10, v44, v45, v10
    v_max3_f32 v10, v46, v47, v10
    v_max3_f32 v10, v48, v49, v10
    v_max3_f32 v10, v50, v51, v10
    v_max3_f32 v10, v52, v53, v10
    v_max3_f32 v10, v54, v55, v10
    s_nop 7
    ds_read_b128 v[72:75], v2 offset:8192
    ds_read_b128 v[76:79], v2 offset:9216
    s_waitcnt lgkmcnt(0)
    v_mfma_f32_32x32x16_bf16 v[40:55], v[72:75], v[16:19], 0
    v_mfma_f32_32x32x16_bf16 v[40:55], v[76:79], v[20:23], v[40:55]
    s_nop 11
    v_max3_f32 v10, v40, v41, v10
    v_max3_f32 v10, v42, v43, v10
    v_max3_f32 v10, v44, v45, v10
    v_max3_f32 v10, v46, v47, v10
    v_max3_f32 v10, v48, v49, v10
    v_max3_f32 v10, v50, v51, v10
    v_max3_f32 v10, v52, v53, v10
    v_max3_f32 v10, v54, v55, v10
    s_nop 7
    ds_read_b128 v[72:75], v2 offset:12288
    ds_read_b128 v[76:79], v2 offset:13312
    s_waitcnt lgkmcnt(0)
    v_mfma_f32_32x32x16_bf16 v[40:55], v[72:75], v[16:19], 0
    v_mfma_f32_32x32x16_bf16 v[40:55], v[76:79], v[20:23], v[40:55]
    s_nop 11
    v_max3_f32 v10, v40, v41, v10
    v_max3_f32 v10, v42, v43, v10
    v_max3_f32 v10, v44, v45, v10
    v_max3_f32 v10, v46, v47, v10
    v_max3_f32 v10, v48, v49, v10
    v_max3_f32 v10, v50, v51, v10
    v_max3_f32 v10, v52, v53, v10
    v_max3_f32 v10, v54, v55, v10
    s_nop 7
    s_add_u32 s54, s54, 1
    s_cmp_lt_u32 s54, 8
    s_cbranch_scc1 FA_FB_LOOP
    v_mov_b32 v11, v10
    s_lshl_b32 s60, s3, 8
    s_xor_b32 s61, s60, 1024
    v_permlane32_swap_b32 v10, v11
    s_add_u32 s60, s60, 157696
    s_add_u32 s61, s61, 157696
    v_max_f32 v10, v10, v11
    v_lshl_add_u32 v8, v0, 2, s60
    v_lshl_add_u32 v9, v0, 2, s61
    ds_write_b32 v8, v10
    s_add_u32 s63, s72, 0
    buffer_load_dwordx4 v[104:107], v1, s[44:47], s63 offen sc1
    buffer_load_dwordx4 v[108:111], v1, s[44:47], s63 offen offset:1024 sc1
    s_waitcnt lgkmcnt(0)
    s_barrier
    ds_read_b32 v11, v9
    s_waitcnt vmcnt(0)
    ds_write_b128 v6, v[104:107] offset:0
    ds_write_b128 v6, v[108:111] offset:1024
    s_waitcnt lgkmcnt(0)
    v_max_f32 v10, v10, v11
    v_sub_f32 v15, 0, v10
    v_and_b32 v12, 0xffff0000, v15
    v_sub_f32 v15, v15, v12
    v_and_b32 v13, 0xffff0000, v15
    v_sub_f32 v15, v15, v13
    v_lshrrev_b32 v14, 16, v15
    v_lshrrev_b32 v12, 16, v12
    v_or_b32 v12, v12, v13
    s_mov_b32 exec_lo, 0
    v_mov_b32 v22, v12
    v_mov_b32 v23, v14
    s_mov_b32 exec_lo, -1
    s_mov_b32 s59, 1
    s_mov_b32 s57, -1
    s_barrier
    s_branch FA_RESTART
FA_END:
    s_endpgm
.section .rodata,"a"
.p2align 6
.amdhsa_kernel gated_mix__grouped_kv_mqa__grouped_kv_mqa__prompt_kernel
  .amdhsa_next_free_vgpr 128
  .amdhsa_next_free_sgpr 102
  .amdhsa_accum_offset 128
  .amdhsa_group_segment_fixed_size 0
  .amdhsa_kernarg_size 112
  .amdhsa_user_sgpr_count 2
  .amdhsa_user_sgpr_kernarg_segment_ptr 1
  .amdhsa_system_sgpr_workgroup_id_x 1
.end_amdhsa_kernel
```
